```python
import torch

def _softmax(x, axis=-1):
    return torch.softmax(x, dim=axis)
def _gelu(x):
    return torch.nn.functional.gelu(x, approximate="tanh")
def _silu(x):
    return torch.nn.functional.silu(x)
def _sigmoid(x):
    return torch.sigmoid(x)
def _layernorm(x, axis=-1, eps=1e-5):
    m = x.mean(dim=axis, keepdim=True)
    v = x.var(dim=axis, keepdim=True, unbiased=False)
    return (x - m) / torch.sqrt(v + eps)
def _scatter_add(tgt, idx, src, axis=0):
    return tgt.clone().index_add_(axis, idx, src)
def _segment_sum(src, seg, n):
    out = torch.zeros((n,) + src.shape[1:], dtype=src.dtype)
    return out.index_add_(0, seg, src)
def _pad(x, pw):
    flat = tuple(v for pair in reversed(pw) for v in pair)
    return torch.nn.functional.pad(x, flat)

kernel_name = 'standalone__modern_conv_block_replknet__vision'

def setup_inputs():

    _w = (lambda a: (lambda t: t.to(torch.bfloat16) if t.is_floating_point() else t)(torch.as_tensor(a)))
    H = W = 224
    C = 96
    K = 3
    return {
        "x": _w((lambda *s: torch.randn(*s, dtype=torch.bfloat16) * 0.05)(1, H, W, C)),
        "dw_large": _w((lambda *s: torch.randn(*s, dtype=torch.bfloat16) * 0.4)(K, K, C) * (1.0 / K)),
        "dw_small": _w((lambda *s: torch.randn(*s, dtype=torch.bfloat16) * 0.4)(5, 5, C) * 0.2),
        "w1": _w((lambda *s: torch.randn(*s, dtype=torch.bfloat16) * 0.4)(C, 4 * C) * (C ** -0.5)),
        "w2": _w((lambda *s: torch.randn(*s, dtype=torch.bfloat16) * 0.1)(4 * C, C) * ((4 * C) ** -0.5)),
    }

def reference(x, dw_large, dw_small, w1, w2):
    B, H, W, C = x.shape
    Kl = dw_large.shape[0]
    pl = (Kl - 1) // 2
    xpl = _pad(x, ((0,0),(pl,pl),(pl,pl),(0,0)))
    out = torch.zeros_like(x)
    for i in range(Kl):
        for j in range(Kl):
            out = out + xpl[:, i:i+H, j:j+W, :] * dw_large[i, j][None, None, None, :]
    Ks = dw_small.shape[0]
    ps = (Ks - 1) // 2
    xps = _pad(x, ((0,0),(ps,ps),(ps,ps),(0,0)))
    for i in range(Ks):
        for j in range(Ks):
            out = out + xps[:, i:i+H, j:j+W, :] * dw_small[i, j][None, None, None, :]
    h = _layernorm(out, axis=-1)
    h = _gelu(torch.einsum('bhwc,ce->bhwe', h, w1))
    h = torch.einsum('bhwe,ec->bhwc', h, w2)
    return x + h
```

```asm
; @launch grid=(256,1,1) block=(256,1,1) lds=163840
.amdgcn_target "amdgcn-amd-amdhsa--gfx950"
.text
.globl standalone__modern_conv_block_replknet__vision_kernel
.p2align 12
.p2align 8
.type standalone__modern_conv_block_replknet__vision_kernel,@function
standalone__modern_conv_block_replknet__vision_kernel:
    s_cmp_ge_u32 s2, 256
    s_cbranch_scc1 L_end
    s_nop 0
    s_load_dwordx2 s[32:33], s[0:1], 16
    s_load_dwordx2 s[28:29], s[0:1], 8
    s_load_dwordx2 s[24:25], s[0:1], 0
    s_load_dwordx2 s[36:37], s[0:1], 24
    s_load_dwordx2 s[40:41], s[0:1], 32
    s_load_dwordx2 s[44:45], s[0:1], 40
    v_lshrrev_b32 v112, 6, v0
    v_and_b32_e64 v138, 63, v0
    s_getpc_b64 s[6:7]
    v_readfirstlane_b32 s48, v112
    s_lshr_b32 s9, s2, 3
    s_mul_i32 s8, s9, 768
    v_mul_u32_u24_e64 v139, 3, v0
    v_and_b32 v139, 0x380, v139
    v_add_u32_e64 v139, s8, v139
    global_load_dword v143, v139, s[6:7]
    v_min_u32 v114, 59, v138
    v_mul_u32_u24 v115, 43, v114
    v_lshrrev_b32_e64 v115, 9, v115
    s_mul_i32 s10, s48, 48
    s_movk_i32 s11, 912
    v_lshl_add_u32 v117, v114, 2, s10
    v_mad_u32_u24 v118, v115, s11, v117
    s_movk_i32 s11, 528
    s_nop 0
    v_subrev_u32 v117, 576, v117
    v_mad_u32_u24 v119, v115, s11, v117
    s_mov_b32 s34, 4800
    s_mov_b32 s35, 0x20000
    s_mov_b32 s30, 1728
    s_mov_b32 s31, 0x20000
    s_mov_b32 s26, 9633792
    s_mov_b32 s27, 0x20000
    s_and_b32 s8, s2, 7
    s_lshl_b32 s8, s8, 5
    s_add_u32 s8, s8, s9
    s_lshr_b32 s9, s8, 4
    s_and_b32 s8, s8, 15
    s_mul_i32 s49, s9, 602112
    s_mul_i32 s50, s8, 2688
    s_mul_i32 s10, s48, 52
    s_min_u32 s10, s10, 152
    v_add_u32 v120, s10, v138
    s_lshl_b32 s62, s10, 4
    s_sub_u32 s11, s50, 384
    v_lshl_add_u32 v121, v120, 4, s11
    s_cmp_eq_u32 s8, 0
    s_cselect_b32 s10, 24, 0
    s_cmp_eq_u32 s8, 15
    s_cselect_b32 s11, 24, s10
    s_sub_u32 s11, 216, s11
    v_subrev_u32 v120, s10, v120
    v_cmp_gt_u32 vcc, s11, v120
    s_sub_u32 s64, s49, 86016
    s_sub_u32 s65, s49, 43008
    v_cndmask_b32_e64 v121, 2.0, v121, vcc
    s_cmp_eq_u32 s9, 0
    s_cselect_b32 s64, 1073741824, s64
    s_cselect_b32 s65, 1073741824, s65
    s_waitcnt lgkmcnt(0)
    buffer_load_dword v16, v118, s[32:35], 0 offen offset:0
    buffer_load_dword v17, v118, s[32:35], 0 offen offset:192
    buffer_load_dword v18, v118, s[32:35], 0 offen offset:384
    buffer_load_dword v19, v118, s[32:35], 0 offen offset:576
    buffer_load_dword v20, v118, s[32:35], 0 offen offset:768
    buffer_load_dword v21, v119, s[28:31], 0 offen offset:0
    buffer_load_dword v22, v119, s[28:31], 0 offen offset:192
    buffer_load_dword v23, v119, s[28:31], 0 offen offset:384
    s_add_u32 m0, s62, 98304
    s_nop 0
    buffer_load_dwordx4 v121, s[24:27], s64 offen  lds
    v_mul_u32_u24 v116, 12, v115
    v_sub_u32_e64 v116, v114, v116
    s_mov_b32 s38, 73728
    s_mov_b32 s39, 0x20000
    s_mov_b32 s42, 73728
    s_mov_b32 s43, 0x20000
    s_lshr_b32 s10, s2, 3
    s_lshl_b32 s10, s10, 8
    v_add_u32 v140, s10, v0
    v_mul_u32_u24 v140, 9, v140
    v_and_b32_e64 v140, -4, v140
    s_and_b32 s66, s48, 1
    s_lshr_b32 s67, s48, 1
    s_lshl_b32 s15, s66, 1
    s_add_u32 s15, s15, s67
    s_mul_i32 s10, s15, 192
    s_mul_i32 s12, s15, 18432
    s_mul_i32 s14, s15, 6144
    s_add_u32 s9, s12, 8256
    s_add_u32 m0, s62, 101776
    s_nop 0
    buffer_load_dwordx4 v121, s[24:27], s49 offen  lds
    v_mul_u32_u24 v122, 784, v116
    v_add_u32 v122, s9, v122
    v_lshl_add_u32 v247, v115, 6, v122
    v_lshl_add_u32 v122, v115, 4, v122
    s_sub_u32 s11, s9, 1344
    v_lshl_add_u32 v125, v138, 4, s11
    v_cmp_gt_u32 vcc, 60, v138
    v_mov_b32 v252, 0
    v_mov_b32 v253, 0
    v_mov_b32 v254, 0
    v_mov_b32 v255, 0
    v_cndmask_b32 v122, v125, v122, vcc
    v_mov_b32_e64 v43, 0
    s_add_u32 m0, s62, 105248
    s_add_u32 s63, s49, 86016
    buffer_load_dwordx4 v121, s[24:27], s63 offen  lds
    v_mov_b32 v47, 0
    v_mov_b32 v48, 0
    v_mov_b32 v52, 0
    v_mov_b32 v59, 0
    v_mov_b32 v63, 0
    v_mov_b32 v64, 0
    v_mov_b32_e64 v68, 0
    ds_write_b128 v122, v[252:255] offset:320
    ds_write_b128 v122, v[252:255] offset:704
    s_add_u32 m0, s62, 108720
    s_add_u32 s63, s49, 172032
    buffer_load_dwordx4 v121, s[24:27], s63 offen  lds
    v_lshrrev_b32 v112, 4, v138
    v_and_b32 v113, 3, v138
    v_bfe_u32 v114, v138, 2, 2
    v_lshlrev_b32 v117, 1, v112
    v_sub_u32 v117, v117, v113
    v_lshl_add_u32 v118, v114, 4, s9
    v_med3_i32 v119, v117, -1, 5
    v_lshl_add_u32 v245, v119, 6, v118
    v_add_u32_e64 v117, 1, v117
    v_med3_i32 v119, v117, -1, 5
    v_lshl_add_u32 v246, v119, 6, v118
    v_lshl_add_u32 v124, v138, 4, s10
    s_movk_i32 s10, 576
    s_add_u32 m0, s62, 112192
    s_add_u32 s63, s49, 258048
    buffer_load_dwordx4 v121, s[24:27], s63 offen  lds
    v_add_u32 v122, 0, v138
    v_mul_u32_u24 v122, 171, v122
    v_lshrrev_b32_e64 v122, 11, v122
    v_mad_u32_u24 v156, v122, s10, v124
    v_add_u32_e64 v122, 64, v138
    v_mul_u32_u24 v122, 171, v122
    v_lshrrev_b32_e64 v122, 11, v122
    v_mad_u32_u24 v157, v122, s10, v124
    v_add_u32 v122, 128, v138
    v_mul_u32_u24 v122, 171, v122
    v_lshrrev_b32_e64 v122, 11, v122
    v_mad_u32_u24 v158, v122, s10, v124
    v_lshl_add_u32 v154, v138, 4, s12
    s_mov_b32 s58, 0x05040100
    s_mov_b32 s59, 0x07060302
    s_mov_b32 s60, 0xffff0000
    v_mov_b32 v248, 0x3727c5ac
    v_mov_b32 v249, v248
    v_and_b32 v115, 1, v138
    v_mul_u32_u24 v115, 6, v115
    v_and_b32 v117, 4, v138
    v_add_u32 v115, v115, v117
    v_and_b32 v116, 2, v138
    v_mul_u32_u24_e64 v116, 3, v116
    v_bfe_u32 v117, v138, 3, 1
    v_lshl_add_u32 v116, v117, 2, v116
    s_mul_i32 s9, s48, 48
    s_add_u32 s9, s9, 98304
    v_lshrrev_b32 v117, 1, v116
    s_add_u32 m0, s62, 115664
    s_add_u32 s63, s49, 344064
    buffer_load_dwordx4 v121, s[24:27], s63 offen  lds
    v_add_u32_e64 v117, v117, v112
    v_mul_u32_u24 v117, 3472, v117
    v_mul_u32_u24 v118, 192, v115
    v_add3_u32 v244, v117, v118, s9
    s_mul_i32 s9, s48, 9456
    s_add_u32 s9, s9, 122880
    v_add_u32 v117, v115, v112
    v_and_b32 v118, 1, v117
    v_mul_u32_u24 v118, 7, v118
    v_lshrrev_b32 v117, 1, v117
    v_and_b32 v119, 2, v138
    v_mul_u32_u24 v119, 14, v119
    v_add3_u32 v117, v117, v118, v119
    s_add_u32 m0, s62, 119136
    s_add_u32 s63, s49, 430080
    buffer_load_dwordx4 v121, s[24:27], s63 offen  lds
    v_lshl_add_u32 v117, v117, 4, s9
    v_and_b32 v118, 8, v138
    v_mul_u32_u24 v118, 56, v118
    v_lshl_add_u32 v155, v118, 1, v117
    v_add_u32 v117, v117, v118
    v_cmp_eq_u32 vcc, 4, v116
    v_mov_b32 v118, 0x40000
    s_nop 0
    v_cndmask_b32 v159, v117, v118, vcc
    v_min_u32_e64 v117, 2, v138
    v_mul_u32_u24 v117, 3152, v117
    v_add_u32 v251, s9, v117
    v_lshrrev_b32 v117, 2, v138
    v_mul_u32_u24 v117, 192, v117
    s_add_u32 m0, s62, 122608
    s_add_u32 s63, s49, 516096
    buffer_load_dwordx4 v121, s[24:27], s63 offen  lds
    v_mul_u32_u24 v118, 3472, v113
    s_mov_b32 s9, 98304
    v_add3_u32 v153, v117, v118, s9
    s_mul_i32 s9, s48, 48
    v_add_u32 v152, s9, v153
    v_lshrrev_b32 v120, 5, v138
    v_and_b32 v122, 1, v112
    s_xor_b32 s9, s15, 1
    v_lshlrev_b32 v118, 5, v122
    v_lshl_add_u32 v118, v113, 3, v118
    v_lshl_add_u32 v117, v120, 3, v114
    v_mul_u32_u24 v117, 192, v117
    s_mul_i32 s10, s15, 18432
    s_mul_i32 s11, s9, 18432
    s_add_u32 m0, s62, 126080
    s_add_u32 s63, s49, 602112
    buffer_load_dwordx4 v121, s[24:27], s63 offen  lds
    v_add3_u32 v144, v117, v118, s10
    v_add3_u32 v148, v117, v118, s11
    v_lshl_add_u32 v117, v120, 2, v114
    v_mul_u32_u24 v117, 192, v117
    s_mul_i32 s11, s9, 6144
    s_add_u32 s10, s14, 73728
    s_add_u32 s11, s11, 73728
    v_add3_u32 v9, v117, v118, s10
    v_add3_u32 v6, v117, v118, s11
    s_lshl_b32 s9, s67, 9
    s_add_u32 s9, s9, 122944
    v_and_b32 v123, 31, v138
    v_mul_u32_u24 v124, 3152, v120
    s_add_u32 m0, s62, 129552
    s_nop 0
    buffer_load_dwordx4 v121, s[24:27], s65 offen  lds
    v_lshl_add_u32 v117, v123, 4, v124
    v_add_u32 v1, s9, v117
    s_mul_i32 s9, s48, 13056
    s_mul_i32 s10, s67, 26112
    s_lshl_b32 s11, s66, 8
    s_add_u32 s10, s10, s11
    v_lshl_add_u32 v2, v138, 4, s9
    v_lshrrev_b32_e64 v128, 2, v138
    v_mul_u32_u24 v117, 1088, v113
    v_lshl_add_u32 v117, v128, 4, v117
    v_add_u32_e64 v3, s10, v117
    v_add_u32 v5, 52224, v3
    v_bfe_u32 v125, v138, 3, 1
    s_add_u32 m0, s62, 133024
    s_add_u32 s63, s49, 43008
    buffer_load_dwordx4 v121, s[24:27], s63 offen  lds
    v_and_b32 v126, 7, v138
    v_cmp_eq_u32 vcc, v125, v122
    s_nop 1
    v_cndmask_b32 v127, 4, v126, vcc
    v_min_u32 v127, 4, v127
    v_and_b32 v117, 4, v127
    v_mul_u32_u24 v117, 48, v117
    v_add_u32 v117, v117, v127
    v_lshl_add_u32 v117, v117, 4, v124
    v_add_u32 v145, 122880, v117
    s_mul_i32 s9, s48, 3264
    s_add_u32 s9, s9, 104448
    v_add_u32_e64 v117, v138, v112
    v_lshl_add_u32 v7, v117, 4, s9
    s_lshl_b32 s3, s48, 7
    s_nop 0
    s_add_u32 s3, s3, 128
    s_add_u32 s9, s3, 122880
    s_add_u32 m0, s62, 136496
    s_add_u32 s63, s49, 129024
    buffer_load_dwordx4 v121, s[24:27], s63 offen  lds
    v_min_u32 v126, 4, v126
    v_and_b32 v117, 4, v126
    v_mul_u32_u24_e64 v117, 48, v117
    v_add_lshl_u32 v117, v117, v126, 4
    v_lshl_add_u32 v118, v125, 1, v122
    v_mul_u32_u24 v118, 3152, v118
    v_lshl_add_u32 v117, v120, 3, v117
    v_add3_u32 v146, v117, v118, s9
    s_mov_b64 exec, 0
    s_cmp_eq_u32 s48, 1
    s_cbranch_scc1 L_pad2
    s_cmp_eq_u32 s48, 2
    s_cbranch_scc1 L_pad3
    s_cmp_eq_u32 s48, 3
    s_cbranch_scc1 L_pad4
    s_branch L_pad1
L_padret4:
    s_branch L_pad5
L_padret1:
L_padret2:
L_padret3:
L_padret5:
    s_mov_b64 exec, -1
    s_waitcnt vmcnt(12)
    v_lshlrev_b32 v24, 16, v16
    v_lshlrev_b32 v25, 16, v17
    v_lshlrev_b32 v26, 16, v18
    v_lshlrev_b32 v27, 16, v19
    v_lshlrev_b32 v28, 16, v20
    v_lshlrev_b32 v29, 16, v21
    v_lshlrev_b32 v30, 16, v22
    v_lshlrev_b32 v31, 16, v23
    v_add_f32 v25, v25, v29
    v_add_f32 v26, v26, v30
    v_add_f32 v27, v27, v31
    v_cvt_pk_bf16_f32 v40, v24, v25
    s_add_u32 m0, s62, 139968
    s_add_u32 s63, s49, 215040
    buffer_load_dwordx4 v121, s[24:27], s63 offen  lds
    v_cvt_pk_bf16_f32 v41, v26, v27
    v_cvt_pk_bf16_f32 v42, v28, 0
    ds_write_b128 v247, v[40:43] offset:0
    v_and_b32 v32, s60, v16
    v_and_b32 v33, s60, v17
    v_and_b32_e64 v34, s60, v18
    v_cvt_pk_bf16_f32 v44, 0, v24
    v_cvt_pk_bf16_f32 v45, v25, v26
    s_add_u32 m0, s62, 143440
    s_add_u32 s63, s49, 301056
    buffer_load_dwordx4 v121, s[24:27], s63 offen  lds
    v_cvt_pk_bf16_f32 v46, v27, v28
    ds_write_b128 v247, v[44:47] offset:16
    v_and_b32 v35, s60, v19
    v_and_b32 v36, s60, v20
    v_and_b32_e64 v37, s60, v21
    v_cvt_pk_bf16_f32 v49, v24, v25
    v_cvt_pk_bf16_f32 v50, v26, v27
    v_cvt_pk_bf16_f32 v51, v28, 0
    s_add_u32 m0, s62, 146912
    s_add_u32 s63, s49, 387072
    buffer_load_dwordx4 v121, s[24:27], s63 offen  lds
    ds_write_b128 v247, v[48:51] offset:32
    v_and_b32 v38, s60, v22
    v_and_b32 v39, s60, v23
    v_add_f32_e64 v33, v33, v37
    v_cvt_pk_bf16_f32 v53, 0, v24
    v_cvt_pk_bf16_f32 v54, v25, v26
    v_cvt_pk_bf16_f32 v55, v27, v28
    ds_write_b128 v247, v[52:55] offset:48
    s_add_u32 m0, s62, 150384
    s_add_u32 s63, s49, 473088
    buffer_load_dwordx4 v121, s[24:27], s63 offen  lds
    v_add_f32 v34, v34, v38
    v_add_f32 v35, v35, v39
    v_cvt_pk_bf16_f32 v56, v32, v33
    v_cvt_pk_bf16_f32 v57, v34, v35
    v_cvt_pk_bf16_f32 v58, v36, 0
    ds_write_b128 v247, v[56:59] offset:384
    v_cvt_pk_bf16_f32 v60, 0, v32
    v_cvt_pk_bf16_f32 v61, v33, v34
    s_add_u32 m0, s62, 153856
    s_add_u32 s63, s49, 559104
    buffer_load_dwordx4 v121, s[24:27], s63 offen  lds
    v_cvt_pk_bf16_f32 v62, v35, v36
    ds_write_b128 v247, v[60:63] offset:400
    v_cvt_pk_bf16_f32 v65, v32, v33
    v_cvt_pk_bf16_f32 v66, v34, v35
    v_cvt_pk_bf16_f32 v67, v36, 0
    ds_write_b128 v247, v[64:67] offset:416
    s_add_u32 m0, s62, 157328
    s_add_u32 s63, s49, 645120
    buffer_load_dwordx4 v121, s[24:27], s63 offen  lds
    v_cvt_pk_bf16_f32 v69, 0, v32
    v_cvt_pk_bf16_f32 v70, v33, v34
    v_cvt_pk_bf16_f32 v71, v35, v36
    ds_write_b128 v247, v[68:71] offset:432
    ds_read_b128 a[0:3], v245 offset:0
    ds_read_b128 a[8:11], v245 offset:384
    ds_read_b128 a[16:19], v245 offset:784
    ds_read_b128 a[24:27], v245 offset:1168
    ds_read_b128 a[32:35], v245 offset:1568
    ds_read_b128 a[40:43], v245 offset:1952
    ds_read_b128 a[48:51], v245 offset:2352
    ds_read_b128 a[56:59], v245 offset:2736
    s_waitcnt vmcnt(9)
    s_barrier
    ds_read_b128 v[160:163], v244 offset:0
    ds_read_b128 v[164:167], v244 offset:192
    v_min_u32 v117, 23, v138
    v_lshrrev_b32 v118, 3, v117
    ds_read_b128 v[168:171], v244 offset:384
    ds_read_b128 v[172:175], v244 offset:576
    v_and_b32 v119, 3, v117
    v_and_b32 v117, 4, v117
    ds_read_b128 v[176:179], v244 offset:768
    ds_read_b128 v[180:183], v244 offset:960
    s_lshl_b32 s9, s48, 4
    s_nop 0
    s_add_u32 s9, s9, 104448
    ds_read_b128 v[184:187], v244 offset:1152
    ds_read_b128 v[188:191], v244 offset:1344
    buffer_load_dword v141, v140, s[36:39], 0 offen
    buffer_load_dword v142, v140, s[40:43], 0 offen
    s_add_u32 m0, s14, 73728
    s_mov_b32 s13, 0
    buffer_load_dwordx4 v154, s[40:43], s13 offen offset:0  lds
    v_lshl_add_u32 v118, v118, 2, v119
    v_mul_u32_u24 v118, 272, v118
    v_lshl_add_u32 v117, v117, 5, s9
    v_add_u32_e64 v8, v117, v118
    s_add_u32 s10, s49, s50
    s_mul_i32 s9, s48, 384
    s_add_u32 s9, s9, s10
    v_lshl_add_u32 v117, v138, 3, s9
    v_mov_b32 v118, 1073741824
    v_cmp_gt_u32 vcc, 24, v138
    s_nop 1
    v_cndmask_b32_e64 v10, v118, v117, vcc
    s_lshl_b32 s9, s48, 4
    s_add_u32 s9, s9, 4
    s_mov_b32 s11, 43008
    s_mov_b32 s8, 0xC82A460
    v_lshl_add_u32 v120, v113, 4, s10
    v_add_u32_e64 v123, s9, v128
    v_add_u32 v123, 128, v123
    v_mul_u32_u24 v118, 4682, v123
    v_lshrrev_b32 v118, 16, v118
    v_mul_u32_u24 v119, 14, v118
    v_sub_u32 v119, v123, v119
    s_waitcnt lgkmcnt(0)
    v_perm_b32 v224, v164, v160, s58
    v_perm_b32 v225, v172, v168, s58
    v_perm_b32 v226, v180, v176, s58
    v_perm_b32 v227, v188, v184, s58
    v_perm_b32 v228, v164, v160, s59
    v_perm_b32 v229, v172, v168, s59
    v_perm_b32 v230, v180, v176, s59
    v_perm_b32 v231, v188, v184, s59
    v_mfma_f32_16x16x32_bf16 v[16:19], a[0:3], v[224:227], 0
    s_mov_b32 s56, 0x3c2aaaab
    ds_read_b128 v[192:195], v244 offset:16
    ds_read_b128 v[196:199], v244 offset:208
    v_perm_b32 v232, v165, v161, s58
    v_perm_b32 v233, v173, v169, s58
    v_perm_b32 v234, v181, v177, s58
    v_perm_b32 v235, v189, v185, s58
    v_mfma_f32_16x16x32_bf16 v[20:23], a[8:11], v[228:231], 0
    ds_read_b128 v[200:203], v244 offset:400
    ds_read_b128 v[204:207], v244 offset:592
    ds_read_b128 a[64:67], v245 offset:3136
    buffer_load_dwordx4 v154, s[40:43], s13 offen offset:1024  lds
    v_perm_b32 v224, v165, v161, s59
    v_perm_b32 v225, v173, v169, s59
    v_perm_b32 v226, v181, v177, s59
    v_perm_b32 v227, v189, v185, s59
    v_mfma_f32_16x16x32_bf16 v[24:27], a[16:19], v[232:235], 0
    s_waitcnt lgkmcnt(5)
    s_mov_b32 s57, s56
    ds_read_b128 v[208:211], v244 offset:784
    ds_read_b128 v[212:215], v244 offset:976
    ds_read_b128 a[72:75], v245 offset:3520
    v_perm_b32 v228, v166, v162, s58
    v_perm_b32 v229, v174, v170, s58
    v_perm_b32 v230, v182, v178, s58
    v_perm_b32 v231, v190, v186, s58
    v_mfma_f32_16x16x32_bf16 v[28:31], a[24:27], v[224:227], 0
    ds_read_b128 v[216:219], v244 offset:1168
    ds_read_b128 v[220:223], v244 offset:1360
    ds_read_b128 a[80:83], v245 offset:3920
    buffer_load_dwordx4 v154, s[40:43], s13 offen offset:2048  lds
    v_perm_b32 v232, v166, v162, s59
    v_perm_b32 v233, v174, v170, s59
    v_perm_b32 v234, v182, v178, s59
    v_perm_b32 v235, v190, v186, s59
    v_mfma_f32_16x16x32_bf16 v[32:35], a[32:35], v[228:231], 0
    s_mov_b32 s54, 0x3eeff558
    ds_read_b128 a[88:91], v245 offset:4304
    ds_read_b128 a[96:99], v245 offset:4704
    v_perm_b32 v224, v167, v163, s58
    v_perm_b32 v225, v175, v171, s58
    v_perm_b32 v226, v183, v179, s58
    v_perm_b32 v227, v191, v187, s58
    v_mfma_f32_16x16x32_bf16 v[36:39], a[40:43], v[232:235], 0
    ds_read_b128 a[104:107], v245 offset:5088
    ds_read_b128 a[112:115], v245 offset:5488
    s_add_u32 m0, s14, 76800
    s_mov_b32 s13, 3072
    buffer_load_dwordx4 v154, s[40:43], s13 offen offset:0  lds
    v_perm_b32 v228, v167, v163, s59
    v_perm_b32 v229, v175, v171, s59
    v_perm_b32 v230, v183, v179, s59
    v_perm_b32 v231, v191, v187, s59
    v_mfma_f32_16x16x32_bf16 v[40:43], a[48:51], v[224:227], 0
    s_waitcnt lgkmcnt(4)
    s_mov_b32 s55, s54
    ds_read_b128 a[120:123], v245 offset:5872
    ds_read_b128 a[128:131], v245 offset:6272
    v_perm_b32 v232, v196, v192, s58
    v_perm_b32 v233, v204, v200, s58
    v_perm_b32 v234, v212, v208, s58
    v_perm_b32 v235, v220, v216, s58
    v_mfma_f32_16x16x32_bf16 v[44:47], a[56:59], v[228:231], 0
    ds_read_b128 v[160:163], v244 offset:32
    ds_read_b128 v[164:167], v244 offset:224
    buffer_load_dwordx4 v154, s[40:43], s13 offen offset:1024  lds
    v_perm_b32 v224, v196, v192, s59
    v_perm_b32 v225, v204, v200, s59
    v_perm_b32 v226, v212, v208, s59
    v_perm_b32 v227, v220, v216, s59
    v_mfma_f32_16x16x32_bf16 v[48:51], a[64:67], v[232:235], 0
    s_mov_b32 s52, 0x409d30fc
    ds_read_b128 v[168:171], v244 offset:416
    ds_read_b128 v[172:175], v244 offset:608
    v_perm_b32 v228, v197, v193, s58
    v_perm_b32 v229, v205, v201, s58
    v_perm_b32 v230, v213, v209, s58
    v_perm_b32 v231, v221, v217, s58
    v_mfma_f32_16x16x32_bf16 v[52:55], a[72:75], v[224:227], 0
    ds_read_b128 v[176:179], v244 offset:800
    ds_read_b128 a[136:139], v245 offset:6656
    buffer_load_dwordx4 v154, s[40:43], s13 offen offset:2048  lds
    v_perm_b32 v232, v197, v193, s59
    v_perm_b32 v233, v205, v201, s59
    v_perm_b32 v234, v213, v209, s59
    v_perm_b32 v235, v221, v217, s59
    v_mfma_f32_16x16x32_bf16 v[56:59], a[80:83], v[228:231], 0
    s_waitcnt lgkmcnt(8)
    s_mov_b32 s53, s52
    ds_read_b128 v[180:183], v244 offset:992
    ds_read_b128 v[184:187], v244 offset:1184
    v_perm_b32 v224, v198, v194, s58
    v_perm_b32 v225, v206, v202, s58
    v_perm_b32 v226, v214, v210, s58
    v_perm_b32 v227, v222, v218, s58
    v_mfma_f32_16x16x32_bf16 v[60:63], a[88:91], v[232:235], 0
    ds_read_b128 v[188:191], v244 offset:1376
    ds_read_b128 a[144:147], v245 offset:7056
    s_add_u32 m0, s12, 0
    s_mov_b32 s13, 0
    buffer_load_dwordx4 v156, s[36:39], s13 offen offset:0  lds
    v_perm_b32 v228, v198, v194, s59
    v_perm_b32 v229, v206, v202, s59
    v_perm_b32 v230, v214, v210, s59
    v_perm_b32 v231, v222, v218, s59
    v_mfma_f32_16x16x32_bf16 v[64:67], a[96:99], v[224:227], 0
    s_mov_b32 s61, 0x3727c5ac
    ds_read_b128 a[152:155], v245 offset:7440
    ds_read_b128 a[160:163], v245 offset:7840
    v_perm_b32 v232, v199, v195, s58
    v_perm_b32 v233, v207, v203, s58
    v_perm_b32 v234, v215, v211, s58
    v_perm_b32 v235, v223, v219, s58
    v_mfma_f32_16x16x32_bf16 v[68:71], a[104:107], v[228:231], 0
    ds_read_b128 a[168:171], v245 offset:8224
    ds_read_b128 a[176:179], v245 offset:8624
    buffer_load_dwordx4 v157, s[36:39], s13 offen offset:1024  lds
    v_perm_b32 v224, v199, v195, s59
    v_perm_b32 v225, v207, v203, s59
    v_perm_b32 v226, v215, v211, s59
    v_perm_b32 v227, v223, v219, s59
    v_mfma_f32_16x16x32_bf16 v[72:75], a[112:115], v[232:235], 0
    s_waitcnt lgkmcnt(4)
    s_nop 0
    ds_read_b128 a[184:187], v245 offset:9008
    ds_read_b128 a[4:7], v246 offset:0
    v_perm_b32 v228, v164, v160, s58
    v_perm_b32 v229, v172, v168, s58
    v_perm_b32 v230, v180, v176, s58
    v_perm_b32 v231, v188, v184, s58
    v_mfma_f32_16x16x32_bf16 v[76:79], a[120:123], v[224:227], 0
    ds_read_b128 a[12:15], v246 offset:384
    ds_read_b128 a[20:23], v246 offset:784
    buffer_load_dwordx4 v158, s[36:39], s13 offen offset:2048  lds
    v_perm_b32 v232, v164, v160, s59
    v_perm_b32 v233, v172, v168, s59
    v_perm_b32 v234, v180, v176, s59
    v_perm_b32 v235, v188, v184, s59
    v_mfma_f32_16x16x32_bf16 v[80:83], a[128:131], v[228:231], 0
    s_waitcnt vmcnt(11)
    s_barrier
    ds_read_b128 a[28:31], v246 offset:1168
    ds_read_b128 a[36:39], v246 offset:1568
    v_perm_b32 v224, v165, v161, s58
    v_perm_b32 v225, v173, v169, s58
    v_perm_b32 v226, v181, v177, s58
    v_perm_b32 v227, v189, v185, s58
    v_mfma_f32_16x16x32_bf16 v[84:87], a[136:139], v[232:235], 0
    ds_read_b128 v[192:195], v244 offset:31248
    ds_read_b128 v[196:199], v244 offset:31440
    s_add_u32 m0, s12, 3072
    s_mov_b32 s13, 12288
    buffer_load_dwordx4 v156, s[36:39], s13 offen offset:0  lds
    v_perm_b32 v228, v165, v161, s59
    v_perm_b32 v229, v173, v169, s59
    v_perm_b32 v230, v181, v177, s59
    v_perm_b32 v231, v189, v185, s59
    v_mfma_f32_16x16x32_bf16 v[88:91], a[144:147], v[224:227], 0
    s_waitcnt lgkmcnt(8)
    s_nop 0
    ds_read_b128 v[200:203], v244 offset:31632
    ds_read_b128 v[204:207], v244 offset:31824
    v_perm_b32 v232, v166, v162, s58
    v_perm_b32 v233, v174, v170, s58
    v_perm_b32 v234, v182, v178, s58
    v_perm_b32 v235, v190, v186, s58
    v_mfma_f32_16x16x32_bf16 v[92:95], a[152:155], v[228:231], 0
    ds_read_b128 v[208:211], v244 offset:32016
    ds_read_b128 v[212:215], v244 offset:32208
    buffer_load_dwordx4 v157, s[36:39], s13 offen offset:1024  lds
    v_perm_b32 v224, v166, v162, s59
    v_perm_b32 v225, v174, v170, s59
    v_perm_b32 v226, v182, v178, s59
L_pad1:
    s_cbranch_execz L_padret1
    s_nop 0
    v_perm_b32 v227, v190, v186, s59
    v_mfma_f32_16x16x32_bf16 v[96:99], a[160:163], v[232:235], 0
    ds_read_b128 v[216:219], v244 offset:32400
    ds_read_b128 v[220:223], v244 offset:32592
    v_perm_b32 v228, v167, v163, s58
    v_perm_b32 v229, v175, v171, s58
    v_perm_b32 v230, v183, v179, s58
    v_perm_b32 v231, v191, v187, s58
    v_mfma_f32_16x16x32_bf16 v[100:103], a[168:171], v[224:227], 0
    ds_read_b128 a[44:47], v246 offset:1952
    ds_read_b128 a[52:55], v246 offset:2352
    buffer_load_dwordx4 v158, s[36:39], s13 offen offset:2048  lds
    v_perm_b32 v232, v167, v163, s59
    v_perm_b32 v233, v175, v171, s59
    v_perm_b32 v234, v183, v179, s59
    v_perm_b32 v235, v191, v187, s59
    v_mfma_f32_16x16x32_bf16 v[104:107], a[176:179], v[228:231], 0
    s_waitcnt lgkmcnt(2)
    s_nop 0
    ds_read_b128 a[60:63], v246 offset:2736
    ds_read_b128 a[68:71], v246 offset:3136
    v_perm_b32 v224, v196, v192, s58
    v_perm_b32 v225, v204, v200, s58
    v_perm_b32 v226, v212, v208, s58
    v_perm_b32 v227, v220, v216, s58
    v_mfma_f32_16x16x32_bf16 v[108:111], a[184:187], v[232:235], 0
    ds_read_b128 v[160:163], v244 offset:31264
    ds_read_b128 v[164:167], v244 offset:31456
    s_add_u32 m0, s12, 6144
    s_mov_b32 s13, 24576
    buffer_load_dwordx4 v156, s[36:39], s13 offen offset:0  lds
    v_perm_b32 v228, v196, v192, s59
    v_perm_b32 v229, v204, v200, s59
    v_perm_b32 v230, v212, v208, s59
    v_perm_b32 v231, v220, v216, s59
    v_mfma_f32_16x16x32_bf16 v[16:19], a[4:7], v[224:227], v[16:19]
    ds_read_b128 v[168:171], v244 offset:31648
    ds_read_b128 v[172:175], v244 offset:31840
    v_perm_b32 v232, v197, v193, s58
    v_perm_b32 v233, v205, v201, s58
    v_perm_b32 v234, v213, v209, s58
    v_perm_b32 v235, v221, v217, s58
    v_mfma_f32_16x16x32_bf16 v[20:23], a[12:15], v[228:231], v[20:23]
    ds_read_b128 v[176:179], v244 offset:32032
    ds_read_b128 a[76:79], v246 offset:3520
    buffer_load_dwordx4 v157, s[36:39], s13 offen offset:1024  lds
    v_perm_b32 v224, v197, v193, s59
    v_perm_b32 v225, v205, v201, s59
    v_perm_b32 v226, v213, v209, s59
    v_perm_b32 v227, v221, v217, s59
    v_mfma_f32_16x16x32_bf16 v[24:27], a[20:23], v[232:235], v[24:27]
    s_waitcnt lgkmcnt(8)
    s_nop 0
    ds_read_b128 v[180:183], v244 offset:32224
    ds_read_b128 v[184:187], v244 offset:32416
    v_perm_b32 v228, v198, v194, s58
    v_perm_b32 v229, v206, v202, s58
    v_perm_b32 v230, v214, v210, s58
    v_perm_b32 v231, v222, v218, s58
    v_mfma_f32_16x16x32_bf16 v[28:31], a[28:31], v[224:227], v[28:31]
    ds_read_b128 v[188:191], v244 offset:32608
    ds_read_b128 a[84:87], v246 offset:3920
    buffer_load_dwordx4 v158, s[36:39], s13 offen offset:2048  lds
    v_perm_b32 v232, v198, v194, s59
    v_perm_b32 v233, v206, v202, s59
    v_perm_b32 v234, v214, v210, s59
    v_perm_b32 v235, v222, v218, s59
    v_mfma_f32_16x16x32_bf16 v[32:35], a[36:39], v[228:231], v[32:35]
    ds_read_b128 a[92:95], v246 offset:4304
    ds_read_b128 a[100:103], v246 offset:4704
    v_perm_b32 v224, v199, v195, s58
    v_perm_b32 v225, v207, v203, s58
    v_perm_b32 v226, v215, v211, s58
    v_perm_b32 v227, v223, v219, s58
    v_mfma_f32_16x16x32_bf16 v[36:39], a[44:47], v[232:235], v[36:39]
    ds_read_b128 a[108:111], v246 offset:5088
    ds_read_b128 a[116:119], v246 offset:5488
    s_add_u32 m0, s12, 9216
    s_mov_b32 s13, 36864
    buffer_load_dwordx4 v156, s[36:39], s13 offen offset:0  lds
    v_perm_b32 v228, v199, v195, s59
    v_perm_b32 v229, v207, v203, s59
    v_perm_b32 v230, v215, v211, s59
    v_perm_b32 v231, v223, v219, s59
    v_mfma_f32_16x16x32_bf16 v[40:43], a[52:55], v[224:227], v[40:43]
    s_waitcnt lgkmcnt(4)
    s_nop 0
    ds_read_b128 a[124:127], v246 offset:5872
    ds_read_b128 a[132:135], v246 offset:6272
    v_perm_b32 v232, v164, v160, s58
    v_perm_b32 v233, v172, v168, s58
    v_perm_b32 v234, v180, v176, s58
    v_perm_b32 v235, v188, v184, s58
    v_mfma_f32_16x16x32_bf16 v[44:47], a[60:63], v[228:231], v[44:47]
    ds_read_b128 v[192:195], v244 offset:31280
    ds_read_b128 v[196:199], v244 offset:31472
    buffer_load_dwordx4 v157, s[36:39], s13 offen offset:1024  lds
    v_perm_b32 v224, v164, v160, s59
    v_perm_b32 v225, v172, v168, s59
    v_perm_b32 v226, v180, v176, s59
    v_perm_b32 v227, v188, v184, s59
    v_mfma_f32_16x16x32_bf16 v[48:51], a[68:71], v[232:235], v[48:51]
    ds_read_b128 v[200:203], v244 offset:31664
    ds_read_b128 v[204:207], v244 offset:31856
    v_perm_b32 v228, v165, v161, s58
    v_perm_b32 v229, v173, v169, s58
    v_perm_b32 v230, v181, v177, s58
    v_perm_b32 v231, v189, v185, s58
    v_mfma_f32_16x16x32_bf16 v[52:55], a[76:79], v[224:227], v[52:55]
    ds_read_b128 v[208:211], v244 offset:32048
    ds_read_b128 a[140:143], v246 offset:6656
    buffer_load_dwordx4 v158, s[36:39], s13 offen offset:2048  lds
    v_perm_b32 v232, v165, v161, s59
    v_perm_b32 v233, v173, v169, s59
    v_perm_b32 v234, v181, v177, s59
    v_perm_b32 v235, v189, v185, s59
    v_mfma_f32_16x16x32_bf16 v[56:59], a[84:87], v[228:231], v[56:59]
    s_waitcnt lgkmcnt(8)
    s_nop 0
    ds_read_b128 v[212:215], v244 offset:32240
    ds_read_b128 v[216:219], v244 offset:32432
    v_perm_b32 v224, v166, v162, s58
    v_perm_b32 v225, v174, v170, s58
    v_perm_b32 v226, v182, v178, s58
    v_perm_b32 v227, v190, v186, s58
    v_mfma_f32_16x16x32_bf16 v[60:63], a[92:95], v[232:235], v[60:63]
    ds_read_b128 v[220:223], v244 offset:32624
    ds_read_b128 a[148:151], v246 offset:7056
    s_add_u32 m0, s12, 12288
    s_mov_b32 s13, 49152
    buffer_load_dwordx4 v156, s[36:39], s13 offen offset:0  lds
    v_perm_b32 v228, v166, v162, s59
    v_perm_b32 v229, v174, v170, s59
    v_perm_b32 v230, v182, v178, s59
    v_perm_b32 v231, v190, v186, s59
    v_mfma_f32_16x16x32_bf16 v[64:67], a[100:103], v[224:227], v[64:67]
    ds_read_b128 a[156:159], v246 offset:7440
    ds_read_b128 a[164:167], v246 offset:7840
    v_perm_b32 v232, v167, v163, s58
    v_perm_b32 v233, v175, v171, s58
    v_perm_b32 v234, v183, v179, s58
    v_perm_b32 v235, v191, v187, s58
    v_mfma_f32_16x16x32_bf16 v[68:71], a[108:111], v[228:231], v[68:71]
    ds_read_b128 a[172:175], v246 offset:8224
    ds_read_b128 a[180:183], v246 offset:8624
    v_perm_b32 v224, v167, v163, s59
    v_perm_b32 v225, v175, v171, s59
    v_perm_b32 v226, v183, v179, s59
    v_perm_b32 v227, v191, v187, s59
    v_mfma_f32_16x16x32_bf16 v[72:75], a[116:119], v[232:235], v[72:75]
    s_waitcnt lgkmcnt(4)
    s_waitcnt vmcnt(13)
    s_barrier
    s_nop 0
    ds_read_b128 a[188:191], v246 offset:9008
    v_perm_b32 v228, v196, v192, s58
    v_perm_b32 v229, v204, v200, s58
    v_perm_b32 v230, v212, v208, s58
    v_perm_b32 v231, v220, v216, s58
    v_mfma_f32_16x16x32_bf16 v[76:79], a[124:127], v[224:227], v[76:79]
    ds_read_b64_tr_b16 a[192:193], v9 offset:0
    ds_read_b64_tr_b16 a[194:195], v9 offset:1536
    ds_read_b64_tr_b16 a[196:197], v9 offset:64
    buffer_load_dwordx4 v157, s[36:39], s13 offen offset:1024  lds
    v_perm_b32 v232, v196, v192, s59
    v_perm_b32 v233, v204, v200, s59
    v_perm_b32 v234, v212, v208, s59
    v_perm_b32 v235, v220, v216, s59
    v_mfma_f32_16x16x32_bf16 v[80:83], a[132:135], v[228:231], v[80:83]
    ds_read_b64_tr_b16 a[198:199], v9 offset:1600
    ds_read_b64_tr_b16 a[200:201], v9 offset:128
    ds_read_b64_tr_b16 a[202:203], v9 offset:1664
    v_perm_b32 v224, v197, v193, s58
    v_perm_b32 v225, v205, v201, s58
    v_perm_b32 v226, v213, v209, s58
    v_perm_b32 v227, v221, v217, s58
    v_mfma_f32_16x16x32_bf16 v[84:87], a[140:143], v[232:235], v[84:87]
    ds_read_b64_tr_b16 a[204:205], v9 offset:3072
    ds_read_b64_tr_b16 a[206:207], v9 offset:4608
    ds_read_b64_tr_b16 a[208:209], v9 offset:3136
    buffer_load_dwordx4 v158, s[36:39], s13 offen offset:2048  lds
    v_perm_b32 v228, v197, v193, s59
    v_perm_b32 v229, v205, v201, s59
    v_perm_b32 v230, v213, v209, s59
    v_perm_b32 v231, v221, v217, s59
    v_mfma_f32_16x16x32_bf16 v[88:91], a[148:151], v[224:227], v[88:91]
    s_waitcnt lgkmcnt(9)
    s_nop 0
    ds_read_b64_tr_b16 a[210:211], v9 offset:4672
    ds_read_b64_tr_b16 a[212:213], v9 offset:3200
    ds_read_b64_tr_b16 a[214:215], v9 offset:4736
    v_perm_b32 v232, v198, v194, s58
    v_perm_b32 v233, v206, v202, s58
    v_perm_b32 v234, v214, v210, s58
    v_perm_b32 v235, v222, v218, s58
    v_mfma_f32_16x16x32_bf16 v[92:95], a[156:159], v[228:231], v[92:95]
    ds_read_b64_tr_b16 a[216:217], v6 offset:0
    ds_read_b64_tr_b16 a[218:219], v6 offset:1536
    ds_read_b64_tr_b16 a[220:221], v6 offset:64
    s_add_u32 m0, s12, 15360
    s_mov_b32 s13, 61440
    buffer_load_dwordx4 v156, s[36:39], s13 offen offset:0  lds
    v_perm_b32 v224, v198, v194, s59
    v_perm_b32 v225, v206, v202, s59
    v_perm_b32 v226, v214, v210, s59
    v_perm_b32 v227, v222, v218, s59
    v_mfma_f32_16x16x32_bf16 v[96:99], a[164:167], v[232:235], v[96:99]
    ds_read_b64_tr_b16 a[222:223], v6 offset:1600
    ds_read_b64_tr_b16 a[224:225], v6 offset:128
    ds_read_b64_tr_b16 a[226:227], v6 offset:1664
    v_perm_b32 v228, v199, v195, s58
    v_perm_b32 v229, v207, v203, s58
    v_perm_b32 v230, v215, v211, s58
    v_perm_b32 v231, v223, v219, s58
    v_mfma_f32_16x16x32_bf16 v[100:103], a[172:175], v[224:227], v[100:103]
    ds_read_b64_tr_b16 a[228:229], v6 offset:3072
    ds_read_b64_tr_b16 a[230:231], v6 offset:4608
    ds_read_b64_tr_b16 a[232:233], v6 offset:3136
    buffer_load_dwordx4 v157, s[36:39], s13 offen offset:1024  lds
    v_perm_b32 v232, v199, v195, s59
    v_perm_b32 v233, v207, v203, s59
    v_perm_b32 v234, v215, v211, s59
    v_perm_b32 v235, v223, v219, s59
    v_mfma_f32_16x16x32_bf16 v[104:107], a[180:183], v[228:231], v[104:107]
    ds_read_b64_tr_b16 a[234:235], v6 offset:4672
    ds_read_b64_tr_b16 a[236:237], v6 offset:3200
    ds_read_b64_tr_b16 a[238:239], v6 offset:4736
    v_mfma_f32_16x16x32_bf16 v[108:111], a[188:191], v[232:235], v[108:111]
    buffer_load_dwordx4 v158, s[36:39], s13 offen offset:2048  lds
    v_pk_mul_f32 v[240:241], v[16:17], v[16:17]
    v_pk_mul_f32 v[242:243], v[18:19], v[18:19]
    v_pk_fma_f32 v[240:241], v[20:21], v[20:21], v[240:241]
    v_pk_add_f32 v[236:237], v[16:17], v[20:21]
    v_pk_fma_f32 v[242:243], v[22:23], v[22:23], v[242:243]
    v_pk_add_f32 v[238:239], v[18:19], v[22:23]
    v_pk_fma_f32 v[240:241], v[24:25], v[24:25], v[240:241]
    v_pk_add_f32 v[236:237], v[236:237], v[24:25]
    v_pk_fma_f32 v[242:243], v[26:27], v[26:27], v[242:243]
    v_pk_add_f32 v[238:239], v[238:239], v[26:27]
    v_pk_fma_f32 v[240:241], v[28:29], v[28:29], v[240:241]
    v_pk_add_f32 v[236:237], v[236:237], v[28:29]
    v_pk_fma_f32 v[242:243], v[30:31], v[30:31], v[242:243]
    v_pk_add_f32 v[238:239], v[238:239], v[30:31]
    v_pk_fma_f32 v[240:241], v[32:33], v[32:33], v[240:241]
    v_pk_add_f32 v[236:237], v[236:237], v[32:33]
    v_pk_fma_f32 v[242:243], v[34:35], v[34:35], v[242:243]
    v_pk_add_f32 v[238:239], v[238:239], v[34:35]
    v_pk_fma_f32 v[240:241], v[36:37], v[36:37], v[240:241]
    v_pk_add_f32 v[236:237], v[236:237], v[36:37]
    v_pk_fma_f32 v[242:243], v[38:39], v[38:39], v[242:243]
    v_pk_add_f32 v[238:239], v[238:239], v[38:39]
    v_pk_fma_f32 v[240:241], v[40:41], v[40:41], v[240:241]
    v_pk_add_f32 v[236:237], v[236:237], v[40:41]
    v_pk_fma_f32 v[242:243], v[42:43], v[42:43], v[242:243]
    v_pk_add_f32 v[238:239], v[238:239], v[42:43]
    v_pk_fma_f32 v[240:241], v[44:45], v[44:45], v[240:241]
    v_pk_add_f32 v[236:237], v[236:237], v[44:45]
    v_pk_fma_f32 v[242:243], v[46:47], v[46:47], v[242:243]
    v_pk_add_f32 v[238:239], v[238:239], v[46:47]
    v_pk_fma_f32 v[240:241], v[48:49], v[48:49], v[240:241]
    v_pk_add_f32 v[236:237], v[236:237], v[48:49]
    v_pk_fma_f32 v[242:243], v[50:51], v[50:51], v[242:243]
    v_pk_add_f32 v[238:239], v[238:239], v[50:51]
    v_pk_fma_f32 v[240:241], v[52:53], v[52:53], v[240:241]
    v_pk_add_f32 v[236:237], v[236:237], v[52:53]
    v_pk_fma_f32 v[242:243], v[54:55], v[54:55], v[242:243]
    v_pk_add_f32 v[238:239], v[238:239], v[54:55]
    v_pk_fma_f32 v[240:241], v[56:57], v[56:57], v[240:241]
    v_pk_add_f32 v[236:237], v[236:237], v[56:57]
    v_pk_fma_f32 v[242:243], v[58:59], v[58:59], v[242:243]
    v_pk_add_f32 v[238:239], v[238:239], v[58:59]
    v_pk_fma_f32 v[240:241], v[60:61], v[60:61], v[240:241]
    v_pk_add_f32 v[236:237], v[236:237], v[60:61]
    v_pk_fma_f32 v[242:243], v[62:63], v[62:63], v[242:243]
    v_pk_add_f32 v[238:239], v[238:239], v[62:63]
    v_pk_fma_f32 v[240:241], v[64:65], v[64:65], v[240:241]
    v_pk_add_f32 v[236:237], v[236:237], v[64:65]
    v_pk_fma_f32 v[242:243], v[66:67], v[66:67], v[242:243]
    v_pk_add_f32 v[238:239], v[238:239], v[66:67]
    v_pk_fma_f32 v[240:241], v[68:69], v[68:69], v[240:241]
    v_pk_add_f32 v[236:237], v[236:237], v[68:69]
    v_pk_fma_f32 v[242:243], v[70:71], v[70:71], v[242:243]
    v_pk_add_f32 v[238:239], v[238:239], v[70:71]
    v_pk_fma_f32 v[240:241], v[72:73], v[72:73], v[240:241]
    v_pk_add_f32 v[236:237], v[236:237], v[72:73]
    v_pk_fma_f32 v[242:243], v[74:75], v[74:75], v[242:243]
    v_pk_add_f32 v[238:239], v[238:239], v[74:75]
    v_pk_fma_f32 v[240:241], v[76:77], v[76:77], v[240:241]
    v_pk_add_f32 v[236:237], v[236:237], v[76:77]
    v_pk_fma_f32 v[242:243], v[78:79], v[78:79], v[242:243]
    v_pk_add_f32 v[238:239], v[238:239], v[78:79]
    v_pk_fma_f32 v[240:241], v[80:81], v[80:81], v[240:241]
    v_pk_add_f32 v[236:237], v[236:237], v[80:81]
    v_pk_fma_f32 v[242:243], v[82:83], v[82:83], v[242:243]
    v_pk_add_f32 v[238:239], v[238:239], v[82:83]
    v_pk_fma_f32 v[240:241], v[84:85], v[84:85], v[240:241]
    v_pk_add_f32 v[236:237], v[236:237], v[84:85]
    v_pk_fma_f32 v[242:243], v[86:87], v[86:87], v[242:243]
    v_pk_add_f32 v[238:239], v[238:239], v[86:87]
    v_pk_fma_f32 v[240:241], v[88:89], v[88:89], v[240:241]
    v_pk_add_f32 v[236:237], v[236:237], v[88:89]
    v_pk_fma_f32 v[242:243], v[90:91], v[90:91], v[242:243]
    v_pk_add_f32 v[238:239], v[238:239], v[90:91]
    v_pk_fma_f32 v[240:241], v[92:93], v[92:93], v[240:241]
    v_pk_add_f32 v[236:237], v[236:237], v[92:93]
    v_pk_fma_f32 v[242:243], v[94:95], v[94:95], v[242:243]
    v_pk_add_f32 v[238:239], v[238:239], v[94:95]
    v_pk_fma_f32 v[240:241], v[96:97], v[96:97], v[240:241]
    v_pk_add_f32 v[236:237], v[236:237], v[96:97]
    v_pk_fma_f32 v[242:243], v[98:99], v[98:99], v[242:243]
    v_pk_add_f32 v[238:239], v[238:239], v[98:99]
    v_pk_fma_f32 v[240:241], v[100:101], v[100:101], v[240:241]
    v_pk_add_f32 v[236:237], v[236:237], v[100:101]
    v_pk_fma_f32 v[242:243], v[102:103], v[102:103], v[242:243]
    v_pk_add_f32 v[238:239], v[238:239], v[102:103]
    v_pk_fma_f32 v[240:241], v[104:105], v[104:105], v[240:241]
    v_pk_add_f32 v[236:237], v[236:237], v[104:105]
    v_pk_fma_f32 v[242:243], v[106:107], v[106:107], v[242:243]
    v_pk_add_f32 v[238:239], v[238:239], v[106:107]
    v_pk_fma_f32 v[240:241], v[108:109], v[108:109], v[240:241]
    v_pk_add_f32 v[236:237], v[236:237], v[108:109]
    v_pk_fma_f32 v[242:243], v[110:111], v[110:111], v[242:243]
    v_pk_add_f32 v[238:239], v[238:239], v[110:111]
    ds_write_b128 v152, v[236:239]
    ds_write_b128 v152, v[240:243] offset:16
    v_lshlrev_b32 v119, 1, v119
    v_subrev_u32 v125, 13, v119
    v_min_u32 v119, v119, v125
    v_and_b32 v125, 14, v118
    v_lshlrev_b32_e64 v125, 1, v125
    v_bfe_u32 v125, s8, v125, 4
    v_and_or_b32 v118, v118, 1, v125
    v_mul_u32_u24 v119, 192, v119
    v_mad_u32_u24 v118, v118, s11, v120
    v_add_u32 v11, v118, v119
    v_subrev_u32 v123, 64, v123
    v_mul_u32_u24 v118, 4682, v123
    v_lshrrev_b32 v118, 16, v118
    v_mul_u32_u24 v119, 14, v118
    v_sub_u32 v119, v123, v119
    v_lshlrev_b32 v119, 1, v119
    v_subrev_u32 v125, 13, v119
    v_min_u32 v119, v119, v125
    v_and_b32 v125, 14, v118
    v_lshlrev_b32 v125, 1, v125
    s_waitcnt lgkmcnt(0)
    s_barrier
    v_bfe_u32 v125, s8, v125, 4
    ds_read_b128 v[224:227], v153 offset:0
    ds_read_b128 v[228:231], v153 offset:16
    v_and_or_b32 v118, v118, 1, v125
    v_mul_u32_u24 v119, 192, v119
    v_mad_u32_u24 v118, v118, s11, v120
    ds_read_b128 v[160:163], v153 offset:48
    ds_read_b128 v[164:167], v153 offset:64
    v_add_u32 v4, v118, v119
    v_subrev_u32 v123, 64, v123
    v_mul_u32_u24 v118, 4682, v123
    ds_read_b128 v[168:171], v153 offset:96
    ds_read_b128 v[172:175], v153 offset:112
    v_lshrrev_b32 v118, 16, v118
    v_mul_u32_u24 v119, 14, v118
    v_sub_u32_e64 v119, v123, v119
    ds_read_b128 v[176:179], v153 offset:144
    ds_read_b128 v[180:183], v153 offset:160
    ds_write_b128 v251, v[252:255] offset:3136
    v_lshlrev_b32 v119, 1, v119
    v_subrev_u32 v125, 13, v119
    v_min_u32 v119, v119, v125
    s_waitcnt lgkmcnt(1)
    v_pk_add_f32 v[224:225], v[224:225], v[160:161]
    v_pk_add_f32 v[168:169], v[168:169], v[176:177]
    v_pk_add_f32 v[226:227], v[226:227], v[162:163]
    v_pk_add_f32 v[170:171], v[170:171], v[178:179]
    v_pk_add_f32 v[228:229], v[228:229], v[164:165]
    v_pk_add_f32 v[172:173], v[172:173], v[180:181]
    v_pk_add_f32 v[230:231], v[230:231], v[166:167]
    v_pk_add_f32 v[174:175], v[174:175], v[182:183]
    v_pk_add_f32 v[224:225], v[224:225], v[168:169]
    v_pk_add_f32 v[226:227], v[226:227], v[170:171]
    v_pk_add_f32 v[228:229], v[228:229], v[172:173]
    v_pk_add_f32 v[230:231], v[230:231], v[174:175]
    v_pk_mul_f32 v[224:225], v[224:225], s[56:57]
    v_pk_mul_f32 v[226:227], v[226:227], s[56:57]
    v_pk_fma_f32 v[228:229], v[228:229], s[56:57], v[248:249]
    v_pk_fma_f32 v[230:231], v[230:231], s[56:57], v[248:249]
    v_and_b32 v125, 14, v118
    v_lshlrev_b32 v125, 1, v125
    v_pk_fma_f32 v[228:229], v[224:225], v[224:225], v[228:229] neg_lo:[1,0,0] neg_hi:[1,0,0]
    v_pk_fma_f32 v[230:231], v[226:227], v[226:227], v[230:231] neg_lo:[1,0,0] neg_hi:[1,0,0]
    v_bfe_u32 v125, s8, v125, 4
    v_and_or_b32 v118, v118, 1, v125
    v_max_f32 v228, s61, v228
    v_max_f32 v229, s61, v229
    v_max_f32 v230, s61, v230
    v_max_f32 v231, s61, v231
    v_rsq_f32 v228, v228
    v_rsq_f32 v229, v229
    v_rsq_f32 v230, v230
    v_rsq_f32 v231, v231
    v_mul_u32_u24 v119, 192, v119
    v_mad_u32_u24 v118, v118, s11, v120
    v_pk_mul_f32 v[228:229], v[228:229], s[54:55]
    v_pk_mul_f32 v[230:231], v[230:231], s[54:55]
    v_add_u32_e64 v0, v118, v119
    v_pk_mul_f32 v[224:225], v[224:225], v[228:229] neg_lo:[1,0] neg_hi:[1,0]
    v_pk_mul_f32 v[226:227], v[226:227], v[230:231] neg_lo:[1,0] neg_hi:[1,0]
    v_pk_fma_f32 v[16:17], v[16:17], v[228:229], v[224:225]
    v_pk_fma_f32 v[20:21], v[20:21], v[228:229], v[224:225]
    v_pk_fma_f32 v[24:25], v[24:25], v[228:229], v[224:225]
    v_pk_fma_f32 v[28:29], v[28:29], v[228:229], v[224:225]
    v_pk_fma_f32 v[32:33], v[32:33], v[228:229], v[224:225]
    v_pk_fma_f32 v[36:37], v[36:37], v[228:229], v[224:225]
    v_pk_fma_f32 v[40:41], v[40:41], v[228:229], v[224:225]
    v_pk_fma_f32 v[44:45], v[44:45], v[228:229], v[224:225]
    v_cvt_pk_bf16_f32 v184, v16, v20
    v_cvt_pk_bf16_f32 v185, v24, v28
    v_cvt_pk_bf16_f32 v186, v32, v36
    v_cvt_pk_bf16_f32 v187, v40, v44
    ds_write_b128 v155, v[184:187] offset:0
    v_pk_fma_f32 v[48:49], v[48:49], v[228:229], v[224:225]
    v_pk_fma_f32 v[52:53], v[52:53], v[228:229], v[224:225]
    v_pk_fma_f32 v[56:57], v[56:57], v[228:229], v[224:225]
    v_pk_fma_f32 v[60:61], v[60:61], v[228:229], v[224:225]
    v_pk_fma_f32 v[50:51], v[50:51], v[230:231], v[226:227]
    v_cvt_pk_bf16_f32 v188, v17, v21
    v_cvt_pk_bf16_f32 v189, v25, v29
    v_cvt_pk_bf16_f32 v190, v33, v37
    v_cvt_pk_bf16_f32 v191, v41, v45
    ds_write_b128 v155, v[188:191] offset:224
    v_pk_fma_f32 v[64:65], v[64:65], v[228:229], v[224:225]
    v_pk_fma_f32 v[68:69], v[68:69], v[228:229], v[224:225]
    v_pk_fma_f32 v[72:73], v[72:73], v[228:229], v[224:225]
    v_pk_fma_f32 v[76:77], v[76:77], v[228:229], v[224:225]
    v_pk_fma_f32 v[54:55], v[54:55], v[230:231], v[226:227]
    v_cvt_pk_bf16_f32 v192, v48, v52
    v_cvt_pk_bf16_f32 v193, v56, v60
    v_cvt_pk_bf16_f32 v194, v64, v68
    v_cvt_pk_bf16_f32 v195, v72, v76
    ds_write_b128 v155, v[192:195] offset:3152
    v_pk_fma_f32 v[80:81], v[80:81], v[228:229], v[224:225]
    v_pk_fma_f32 v[84:85], v[84:85], v[228:229], v[224:225]
    v_pk_fma_f32 v[88:89], v[88:89], v[228:229], v[224:225]
    v_pk_fma_f32 v[92:93], v[92:93], v[228:229], v[224:225]
    v_pk_fma_f32 v[58:59], v[58:59], v[230:231], v[226:227]
    v_cvt_pk_bf16_f32 v196, v49, v53
    v_cvt_pk_bf16_f32 v197, v57, v61
    v_cvt_pk_bf16_f32 v198, v65, v69
    v_cvt_pk_bf16_f32 v199, v73, v77
    ds_write_b128 v155, v[196:199] offset:3376
    v_pk_fma_f32 v[96:97], v[96:97], v[228:229], v[224:225]
    v_pk_fma_f32 v[100:101], v[100:101], v[228:229], v[224:225]
    v_pk_fma_f32 v[104:105], v[104:105], v[228:229], v[224:225]
    v_pk_fma_f32 v[108:109], v[108:109], v[228:229], v[224:225]
    v_pk_fma_f32 v[62:63], v[62:63], v[230:231], v[226:227]
    v_cvt_pk_bf16_f32 v200, v80, v84
    v_cvt_pk_bf16_f32 v201, v88, v92
    v_cvt_pk_bf16_f32 v202, v96, v100
    v_cvt_pk_bf16_f32 v203, v104, v108
    ds_write_b128 v155, v[200:203] offset:6304
    v_pk_fma_f32 v[66:67], v[66:67], v[230:231], v[226:227]
    v_pk_fma_f32 v[70:71], v[70:71], v[230:231], v[226:227]
    v_pk_fma_f32 v[74:75], v[74:75], v[230:231], v[226:227]
    v_pk_fma_f32 v[78:79], v[78:79], v[230:231], v[226:227]
    v_cvt_pk_bf16_f32 v204, v81, v85
    v_cvt_pk_bf16_f32 v205, v89, v93
    v_cvt_pk_bf16_f32 v206, v97, v101
    v_cvt_pk_bf16_f32 v207, v105, v109
    ds_write_b128 v155, v[204:207] offset:6528
    s_waitcnt vmcnt(0)
    s_nop 0
    ds_read_b64_tr_b16 a[0:1], v144 offset:0
    ds_read_b64_tr_b16 a[2:3], v144 offset:768
    ds_read_b64_tr_b16 a[4:5], v144 offset:3072
    ds_read_b64_tr_b16 a[6:7], v144 offset:3840
    ds_read_b64_tr_b16 a[8:9], v144 offset:6144
    ds_read_b64_tr_b16 a[10:11], v144 offset:6912
    ds_read_b64_tr_b16 a[12:13], v144 offset:9216
    ds_read_b64_tr_b16 a[14:15], v144 offset:9984
    ds_read_b64_tr_b16 a[16:17], v144 offset:12288
    ds_read_b64_tr_b16 a[18:19], v144 offset:13056
    ds_read_b64_tr_b16 a[20:21], v144 offset:15360
    ds_read_b64_tr_b16 a[22:23], v144 offset:16128
    s_waitcnt lgkmcnt(12)
    s_barrier
    v_cvt_pk_bf16_f32 v168, v50, v54
    ds_read_b128 v[192:195], v1 offset:0
    ds_read_b128 v[196:199], v1 offset:6304
    v_cvt_pk_bf16_f32 v169, v58, v62
    v_cvt_pk_bf16_f32 v170, v66, v70
    ds_read_b128 v[200:203], v1 offset:12608
    ds_read_b128 v[204:207], v1 offset:18912
    v_cvt_pk_bf16_f32 v171, v74, v78
    v_cvt_pk_bf16_f32 v172, v51, v55
    ds_read_b128 v[208:211], v1 offset:25216
    ds_read_b128 v[212:215], v1 offset:31520
    v_cvt_pk_bf16_f32 v173, v59, v63
    v_cvt_pk_bf16_f32 v174, v67, v71
    v_mov_b32 v216, v146
    v_mov_b32 v217, v145
    v_mov_b32 v218, v154
    v_mov_b32 v219, v159
    v_mov_b32_e64 v220, v148
    v_cvt_pk_bf16_f32 v175, v75, v79
    v_pk_fma_f32 v[82:83], v[82:83], v[230:231], v[226:227]
    v_pk_fma_f32 v[86:87], v[86:87], v[230:231], v[226:227]
    v_pk_fma_f32 v[90:91], v[90:91], v[230:231], v[226:227]
    v_pk_fma_f32 v[94:95], v[94:95], v[230:231], v[226:227]
    v_pk_fma_f32 v[98:99], v[98:99], v[230:231], v[226:227]
    v_pk_fma_f32 v[102:103], v[102:103], v[230:231], v[226:227]
    v_pk_fma_f32 v[106:107], v[106:107], v[230:231], v[226:227]
    v_pk_fma_f32 v[110:111], v[110:111], v[230:231], v[226:227]
    v_pk_fma_f32 v[18:19], v[18:19], v[230:231], v[226:227]
    v_pk_fma_f32 v[22:23], v[22:23], v[230:231], v[226:227]
    v_pk_fma_f32 v[26:27], v[26:27], v[230:231], v[226:227]
    v_pk_fma_f32 v[30:31], v[30:31], v[230:231], v[226:227]
    v_pk_fma_f32 v[34:35], v[34:35], v[230:231], v[226:227]
    v_pk_fma_f32 v[38:39], v[38:39], v[230:231], v[226:227]
    v_pk_fma_f32 v[42:43], v[42:43], v[230:231], v[226:227]
    v_pk_fma_f32 v[46:47], v[46:47], v[230:231], v[226:227]
    s_waitcnt lgkmcnt(2)
    s_waitcnt lgkmcnt(0)
    v_mfma_f32_32x32x16_bf16 v[64:79], a[0:3], v[192:195], 0
    ds_read_b64_tr_b16 a[24:25], v144 offset:64
    ds_read_b64_tr_b16 a[26:27], v144 offset:832
    v_cvt_pk_bf16_f32 v176, v82, v86
    v_cvt_pk_bf16_f32 v177, v90, v94
    v_cvt_pk_bf16_f32 v178, v98, v102
    v_cvt_pk_bf16_f32 v179, v106, v110
    v_mfma_f32_32x32x16_bf16 v[64:79], a[4:7], v[196:199], v[64:79]
    ds_read_b64_tr_b16 a[28:29], v144 offset:3136
    ds_read_b64_tr_b16 a[30:31], v144 offset:3904
    v_cvt_pk_bf16_f32 v180, v83, v87
    v_cvt_pk_bf16_f32 v181, v91, v95
    v_cvt_pk_bf16_f32 v182, v99, v103
    v_cvt_pk_bf16_f32 v183, v107, v111
    v_mfma_f32_32x32x16_bf16 v[64:79], a[8:11], v[200:203], v[64:79]
    ds_read_b64_tr_b16 a[32:33], v144 offset:6208
    ds_read_b64_tr_b16 a[34:35], v144 offset:6976
    v_cvt_pk_bf16_f32 v160, v18, v22
L_pad2:
    s_cbranch_execz L_padret2
    s_nop 0
    v_cvt_pk_bf16_f32 v161, v26, v30
    v_cvt_pk_bf16_f32 v162, v34, v38
    v_cvt_pk_bf16_f32 v163, v42, v46
    v_mfma_f32_32x32x16_bf16 v[64:79], a[12:15], v[204:207], v[64:79]
    ds_read_b64_tr_b16 a[36:37], v144 offset:9280
    ds_read_b64_tr_b16 a[38:39], v144 offset:10048
    v_cvt_pk_bf16_f32 v164, v19, v23
    v_mfma_f32_32x32x16_bf16 v[64:79], a[16:19], v[208:211], v[64:79]
    ds_read_b64_tr_b16 a[40:41], v144 offset:12352
    ds_read_b64_tr_b16 a[42:43], v144 offset:13120
    ds_read_b64_tr_b16 a[44:45], v144 offset:15424
    ds_read_b64_tr_b16 a[46:47], v144 offset:16192
    v_mfma_f32_32x32x16_bf16 v[64:79], a[20:23], v[212:215], v[64:79]
    ds_write_b128 v219, v[168:171] offset:4944
    v_cvt_pk_bf16_f32 v165, v27, v31
    v_cvt_pk_bf16_f32 v166, v35, v39
    v_cvt_pk_bf16_f32 v167, v43, v47
    s_nop 7
    s_nop 0
    v_pk_fma_f32 v[112:113], v[64:65], v[64:65], s[52:53]
    v_pk_fma_f32 v[114:115], v[66:67], v[66:67], s[52:53]
    v_pk_fma_f32 v[116:117], v[68:69], v[68:69], s[52:53]
    v_pk_fma_f32 v[118:119], v[70:71], v[70:71], s[52:53]
    v_pk_fma_f32 v[120:121], v[72:73], v[72:73], s[52:53]
    v_pk_fma_f32 v[122:123], v[74:75], v[74:75], s[52:53]
    v_pk_fma_f32 v[124:125], v[76:77], v[76:77], s[52:53]
    v_pk_fma_f32 v[126:127], v[78:79], v[78:79], s[52:53]
    v_pk_mul_f32 v[112:113], v[64:65], v[112:113] neg_lo:[1,0] neg_hi:[1,0]
    v_pk_mul_f32 v[114:115], v[66:67], v[114:115] neg_lo:[1,0] neg_hi:[1,0]
    v_pk_mul_f32 v[116:117], v[68:69], v[116:117] neg_lo:[1,0] neg_hi:[1,0]
    v_pk_mul_f32 v[118:119], v[70:71], v[118:119] neg_lo:[1,0] neg_hi:[1,0]
    v_pk_mul_f32 v[120:121], v[72:73], v[120:121] neg_lo:[1,0] neg_hi:[1,0]
    v_pk_mul_f32 v[122:123], v[74:75], v[122:123] neg_lo:[1,0] neg_hi:[1,0]
    v_pk_mul_f32 v[124:125], v[76:77], v[124:125] neg_lo:[1,0] neg_hi:[1,0]
    v_pk_mul_f32 v[126:127], v[78:79], v[126:127] neg_lo:[1,0] neg_hi:[1,0]
    s_waitcnt lgkmcnt(1)
    s_nop 0
    v_mfma_f32_32x32x16_bf16 v[80:95], a[24:27], v[192:195], 0
    ds_read_b64_tr_b16 a[48:49], v144 offset:128
    ds_read_b64_tr_b16 a[50:51], v144 offset:896
    s_add_u32 m0, s14, 98304
    s_mov_b32 s13, 6144
    buffer_load_dwordx4 v218, s[40:43], s13 offen offset:0  lds
    v_exp_f32 v112, v112
    v_exp_f32 v113, v113
    v_mfma_f32_32x32x16_bf16 v[80:95], a[28:31], v[196:199], v[80:95]
    ds_read_b64_tr_b16 a[52:53], v144 offset:3200
    ds_read_b64_tr_b16 a[54:55], v144 offset:3968
    buffer_load_dwordx4 v218, s[40:43], s13 offen offset:1024  lds
    v_exp_f32 v114, v114
    v_exp_f32 v115, v115
    v_mfma_f32_32x32x16_bf16 v[80:95], a[32:35], v[200:203], v[80:95]
    ds_read_b64_tr_b16 a[56:57], v144 offset:6272
    ds_read_b64_tr_b16 a[58:59], v144 offset:7040
    buffer_load_dwordx4 v218, s[40:43], s13 offen offset:2048  lds
    v_exp_f32 v116, v116
    v_exp_f32 v117, v117
    v_mfma_f32_32x32x16_bf16 v[80:95], a[36:39], v[204:207], v[80:95]
    ds_read_b64_tr_b16 a[60:61], v144 offset:9344
    ds_read_b64_tr_b16 a[62:63], v144 offset:10112
    s_add_u32 m0, s14, 101376
    s_mov_b32 s13, 9216
    buffer_load_dwordx4 v218, s[40:43], s13 offen offset:0  lds
    v_exp_f32 v118, v118
    v_exp_f32 v119, v119
    v_mfma_f32_32x32x16_bf16 v[80:95], a[40:43], v[208:211], v[80:95]
    ds_read_b64_tr_b16 a[64:65], v144 offset:12416
    ds_read_b64_tr_b16 a[66:67], v144 offset:13184
    buffer_load_dwordx4 v218, s[40:43], s13 offen offset:1024  lds
    v_exp_f32 v120, v120
    v_exp_f32 v121, v121
    v_mfma_f32_32x32x16_bf16 v[80:95], a[44:47], v[212:215], v[80:95]
    ds_read_b64_tr_b16 a[68:69], v144 offset:15488
    ds_read_b64_tr_b16 a[70:71], v144 offset:16256
    buffer_load_dwordx4 v218, s[40:43], s13 offen offset:2048  lds
    v_exp_f32 v122, v122
    v_exp_f32 v123, v123
    v_exp_f32 v124, v124
    v_exp_f32 v125, v125
    v_exp_f32 v126, v126
    v_exp_f32 v127, v127
    v_pk_fma_f32 v[112:113], v[112:113], s[54:55], s[54:55]
    v_pk_fma_f32 v[114:115], v[114:115], s[54:55], s[54:55]
    v_pk_fma_f32 v[116:117], v[116:117], s[54:55], s[54:55]
    v_pk_fma_f32 v[118:119], v[118:119], s[54:55], s[54:55]
    v_pk_fma_f32 v[120:121], v[120:121], s[54:55], s[54:55]
    v_pk_fma_f32 v[122:123], v[122:123], s[54:55], s[54:55]
    v_pk_fma_f32 v[124:125], v[124:125], s[54:55], s[54:55]
    v_pk_fma_f32 v[126:127], v[126:127], s[54:55], s[54:55]
    v_pk_fma_f32 v[128:129], v[80:81], v[80:81], s[52:53]
    v_pk_fma_f32 v[130:131], v[82:83], v[82:83], s[52:53]
    v_pk_fma_f32 v[132:133], v[84:85], v[84:85], s[52:53]
    v_pk_fma_f32 v[134:135], v[86:87], v[86:87], s[52:53]
    v_pk_fma_f32 v[136:137], v[88:89], v[88:89], s[52:53]
    v_pk_fma_f32 v[138:139], v[90:91], v[90:91], s[52:53]
    v_pk_fma_f32 v[140:141], v[92:93], v[92:93], s[52:53]
    v_pk_fma_f32 v[142:143], v[94:95], v[94:95], s[52:53]
    v_pk_mul_f32 v[128:129], v[80:81], v[128:129] neg_lo:[1,0] neg_hi:[1,0]
    v_pk_mul_f32 v[130:131], v[82:83], v[130:131] neg_lo:[1,0] neg_hi:[1,0]
    v_pk_mul_f32 v[132:133], v[84:85], v[132:133] neg_lo:[1,0] neg_hi:[1,0]
    v_pk_mul_f32 v[134:135], v[86:87], v[134:135] neg_lo:[1,0] neg_hi:[1,0]
    v_pk_mul_f32 v[136:137], v[88:89], v[136:137] neg_lo:[1,0] neg_hi:[1,0]
    v_pk_mul_f32 v[138:139], v[90:91], v[138:139] neg_lo:[1,0] neg_hi:[1,0]
    v_pk_mul_f32 v[140:141], v[92:93], v[140:141] neg_lo:[1,0] neg_hi:[1,0]
    v_pk_mul_f32 v[142:143], v[94:95], v[142:143] neg_lo:[1,0] neg_hi:[1,0]
    s_waitcnt lgkmcnt(0)
    s_nop 0
    v_mfma_f32_32x32x16_bf16 v[96:111], a[48:51], v[192:195], 0
    ds_read_b64_tr_b16 a[72:73], v220 offset:0
    ds_read_b64_tr_b16 a[74:75], v220 offset:768
    s_add_u32 m0, s14, 73728
    s_mov_b32 s13, 12288
    buffer_load_dwordx4 v218, s[40:43], s13 offen offset:0  lds
    v_exp_f32 v128, v128
    v_exp_f32 v129, v129
    v_mfma_f32_32x32x16_bf16 v[96:111], a[52:55], v[196:199], v[96:111]
    ds_read_b64_tr_b16 a[76:77], v220 offset:3072
    ds_read_b64_tr_b16 a[78:79], v220 offset:3840
    buffer_load_dwordx4 v218, s[40:43], s13 offen offset:1024  lds
    v_exp_f32 v130, v130
    v_exp_f32 v131, v131
    v_mfma_f32_32x32x16_bf16 v[96:111], a[56:59], v[200:203], v[96:111]
    ds_read_b64_tr_b16 a[80:81], v220 offset:6144
    ds_read_b64_tr_b16 a[82:83], v220 offset:6912
    buffer_load_dwordx4 v218, s[40:43], s13 offen offset:2048  lds
    v_exp_f32 v132, v132
    v_exp_f32 v133, v133
    v_mfma_f32_32x32x16_bf16 v[96:111], a[60:63], v[204:207], v[96:111]
    ds_read_b64_tr_b16 a[84:85], v220 offset:9216
    ds_read_b64_tr_b16 a[86:87], v220 offset:9984
    s_add_u32 m0, s14, 76800
    s_mov_b32 s13, 15360
    buffer_load_dwordx4 v218, s[40:43], s13 offen offset:0  lds
    v_exp_f32 v134, v134
    v_exp_f32 v135, v135
    v_mfma_f32_32x32x16_bf16 v[96:111], a[64:67], v[208:211], v[96:111]
    ds_read_b64_tr_b16 a[88:89], v220 offset:12288
    ds_read_b64_tr_b16 a[90:91], v220 offset:13056
    buffer_load_dwordx4 v218, s[40:43], s13 offen offset:1024  lds
    v_exp_f32 v136, v136
    v_exp_f32 v137, v137
    v_mfma_f32_32x32x16_bf16 v[96:111], a[68:71], v[212:215], v[96:111]
    ds_read_b64_tr_b16 a[92:93], v220 offset:15360
    ds_read_b64_tr_b16 a[94:95], v220 offset:16128
    buffer_load_dwordx4 v218, s[40:43], s13 offen offset:2048  lds
    v_exp_f32 v138, v138
    v_exp_f32 v139, v139
    v_exp_f32 v140, v140
    v_exp_f32 v141, v141
    v_exp_f32 v142, v142
    v_exp_f32 v143, v143
    v_rcp_f32 v112, v112
    v_rcp_f32 v113, v113
    v_rcp_f32 v114, v114
    v_rcp_f32 v115, v115
    v_rcp_f32 v116, v116
    v_rcp_f32 v117, v117
    v_rcp_f32 v118, v118
    v_rcp_f32 v119, v119
    v_rcp_f32 v120, v120
    v_rcp_f32 v121, v121
    v_rcp_f32 v122, v122
    v_rcp_f32 v123, v123
    v_rcp_f32 v124, v124
    v_rcp_f32 v125, v125
    v_rcp_f32 v126, v126
    v_rcp_f32 v127, v127
    v_pk_fma_f32 v[128:129], v[128:129], s[54:55], s[54:55]
    v_pk_fma_f32 v[130:131], v[130:131], s[54:55], s[54:55]
    v_pk_fma_f32 v[132:133], v[132:133], s[54:55], s[54:55]
    v_pk_fma_f32 v[134:135], v[134:135], s[54:55], s[54:55]
    v_pk_fma_f32 v[136:137], v[136:137], s[54:55], s[54:55]
    v_pk_fma_f32 v[138:139], v[138:139], s[54:55], s[54:55]
    v_pk_fma_f32 v[140:141], v[140:141], s[54:55], s[54:55]
    v_pk_fma_f32 v[142:143], v[142:143], s[54:55], s[54:55]
    v_pk_mul_f32 v[112:113], v[64:65], v[112:113]
    v_pk_mul_f32 v[114:115], v[66:67], v[114:115]
    v_pk_mul_f32 v[116:117], v[68:69], v[116:117]
    v_pk_mul_f32 v[118:119], v[70:71], v[118:119]
    v_pk_mul_f32 v[120:121], v[72:73], v[120:121]
    v_pk_mul_f32 v[122:123], v[74:75], v[122:123]
    v_pk_mul_f32 v[124:125], v[76:77], v[124:125]
    v_pk_mul_f32 v[126:127], v[78:79], v[126:127]
    v_pk_fma_f32 v[144:145], v[96:97], v[96:97], s[52:53]
    v_pk_fma_f32 v[146:147], v[98:99], v[98:99], s[52:53]
    v_pk_fma_f32 v[148:149], v[100:101], v[100:101], s[52:53]
    v_pk_fma_f32 v[150:151], v[102:103], v[102:103], s[52:53]
    v_pk_fma_f32 v[152:153], v[104:105], v[104:105], s[52:53]
    v_pk_fma_f32 v[154:155], v[106:107], v[106:107], s[52:53]
    v_pk_fma_f32 v[156:157], v[108:109], v[108:109], s[52:53]
    v_pk_fma_f32 v[158:159], v[110:111], v[110:111], s[52:53]
    v_pk_mul_f32 v[144:145], v[96:97], v[144:145] neg_lo:[1,0] neg_hi:[1,0]
    v_pk_mul_f32 v[146:147], v[98:99], v[146:147] neg_lo:[1,0] neg_hi:[1,0]
    v_pk_mul_f32 v[148:149], v[100:101], v[148:149] neg_lo:[1,0] neg_hi:[1,0]
    v_pk_mul_f32 v[150:151], v[102:103], v[150:151] neg_lo:[1,0] neg_hi:[1,0]
    v_pk_mul_f32 v[152:153], v[104:105], v[152:153] neg_lo:[1,0] neg_hi:[1,0]
    v_pk_mul_f32 v[154:155], v[106:107], v[154:155] neg_lo:[1,0] neg_hi:[1,0]
    v_pk_mul_f32 v[156:157], v[108:109], v[156:157] neg_lo:[1,0] neg_hi:[1,0]
    v_pk_mul_f32 v[158:159], v[110:111], v[158:159] neg_lo:[1,0] neg_hi:[1,0]
    s_waitcnt vmcnt(6) lgkmcnt(0)
    s_nop 0
    v_mfma_f32_32x32x16_bf16 v[64:79], a[72:75], v[192:195], 0
    ds_read_b64_tr_b16 a[96:97], v220 offset:64
    ds_read_b64_tr_b16 a[98:99], v220 offset:832
    v_cvt_pk_bf16_f32 v252, v112, v113
    v_cvt_pk_bf16_f32 v253, v114, v115
    v_cvt_pk_bf16_f32 v254, v116, v117
    v_cvt_pk_bf16_f32 v255, v118, v119
    v_mfma_f32_32x32x16_bf16 v[64:79], a[76:79], v[196:199], v[64:79]
    ds_read_b64_tr_b16 a[100:101], v220 offset:3136
    ds_read_b64_tr_b16 a[102:103], v220 offset:3904
    v_cvt_pk_bf16_f32 v12, v120, v121
    v_cvt_pk_bf16_f32 v13, v122, v123
    v_cvt_pk_bf16_f32 v14, v124, v125
    v_cvt_pk_bf16_f32 v15, v126, v127
    v_mfma_f32_32x32x16_bf16 v[64:79], a[80:83], v[200:203], v[64:79]
    ds_read_b64_tr_b16 a[104:105], v220 offset:6208
    ds_read_b64_tr_b16 a[106:107], v220 offset:6976
    v_exp_f32 v144, v144
    v_exp_f32 v145, v145
    v_mfma_f32_32x32x16_bf16 v[64:79], a[84:87], v[204:207], v[64:79]
    ds_read_b64_tr_b16 a[108:109], v220 offset:9280
    ds_read_b64_tr_b16 a[110:111], v220 offset:10048
    v_exp_f32 v146, v146
    v_exp_f32 v147, v147
    v_mfma_f32_32x32x16_bf16 v[64:79], a[88:91], v[208:211], v[64:79]
    ds_write_b128 v219, v[172:175] offset:5168
    v_exp_f32_e64 v148, v148
    v_mfma_f32_32x32x16_bf16 v[64:79], a[92:95], v[212:215], v[64:79]
    ds_read_b64_tr_b16 a[112:113], v220 offset:12352
    ds_read_b64_tr_b16 a[114:115], v220 offset:13120
    v_exp_f32 v149, v149
    v_exp_f32 v150, v150
    v_mfma_f32_32x32x16_bf16 v[16:31], a[192:195], v[252:255], 0
    ds_read_b64_tr_b16 a[116:117], v220 offset:15424
    ds_read_b64_tr_b16 a[118:119], v220 offset:16192
    v_exp_f32 v151, v151
    v_exp_f32 v152, v152
    v_mfma_f32_32x32x16_bf16 v[16:31], a[204:207], v[12:15], v[16:31]
    ds_read_b64_tr_b16 a[144:145], v9 offset:24576
    ds_read_b64_tr_b16 a[146:147], v9 offset:26112
    v_exp_f32 v153, v153
    v_exp_f32 v154, v154
    v_mfma_f32_32x32x16_bf16 v[32:47], a[196:199], v[252:255], 0
    ds_write_b128 v219, v[176:179] offset:8096
    v_exp_f32_e64 v155, v155
    v_mfma_f32_32x32x16_bf16 v[32:47], a[208:211], v[12:15], v[32:47]
    ds_read_b64_tr_b16 a[148:149], v9 offset:24640
    ds_read_b64_tr_b16 a[150:151], v9 offset:26176
    v_exp_f32 v156, v156
    v_exp_f32 v157, v157
    v_mfma_f32_32x32x16_bf16 v[48:63], a[200:203], v[252:255], 0
    ds_read_b64_tr_b16 a[152:153], v9 offset:24704
    ds_read_b64_tr_b16 a[154:155], v9 offset:26240
    v_exp_f32 v158, v158
    v_exp_f32 v159, v159
    v_mfma_f32_32x32x16_bf16 v[48:63], a[212:215], v[12:15], v[48:63]
    ds_write_b128 v219, v[180:183] offset:8320
    v_rcp_f32 v128, v128
    v_rcp_f32 v129, v129
    v_rcp_f32 v130, v130
    v_rcp_f32 v131, v131
    v_rcp_f32 v132, v132
    v_rcp_f32 v133, v133
    v_rcp_f32 v134, v134
    v_rcp_f32 v135, v135
    v_rcp_f32 v136, v136
    v_rcp_f32 v137, v137
    v_rcp_f32 v138, v138
    v_rcp_f32 v139, v139
    v_rcp_f32 v140, v140
    v_rcp_f32 v141, v141
    v_rcp_f32 v142, v142
    v_rcp_f32 v143, v143
    v_pk_fma_f32 v[144:145], v[144:145], s[54:55], s[54:55]
    v_pk_fma_f32 v[146:147], v[146:147], s[54:55], s[54:55]
    v_pk_fma_f32 v[148:149], v[148:149], s[54:55], s[54:55]
    v_pk_fma_f32 v[150:151], v[150:151], s[54:55], s[54:55]
    v_pk_fma_f32 v[152:153], v[152:153], s[54:55], s[54:55]
    v_pk_fma_f32 v[154:155], v[154:155], s[54:55], s[54:55]
    v_pk_fma_f32 v[156:157], v[156:157], s[54:55], s[54:55]
    v_pk_fma_f32 v[158:159], v[158:159], s[54:55], s[54:55]
    v_pk_mul_f32 v[128:129], v[80:81], v[128:129]
    v_pk_mul_f32 v[130:131], v[82:83], v[130:131]
    v_pk_mul_f32 v[132:133], v[84:85], v[132:133]
    v_pk_mul_f32 v[134:135], v[86:87], v[134:135]
    v_pk_mul_f32 v[136:137], v[88:89], v[136:137]
    v_pk_mul_f32 v[138:139], v[90:91], v[138:139]
    v_pk_mul_f32 v[140:141], v[92:93], v[140:141]
    v_pk_mul_f32 v[142:143], v[94:95], v[142:143]
    v_pk_fma_f32 v[112:113], v[64:65], v[64:65], s[52:53]
    v_pk_fma_f32 v[114:115], v[66:67], v[66:67], s[52:53]
    v_pk_fma_f32 v[116:117], v[68:69], v[68:69], s[52:53]
    v_pk_fma_f32 v[118:119], v[70:71], v[70:71], s[52:53]
    v_pk_fma_f32 v[120:121], v[72:73], v[72:73], s[52:53]
    v_pk_fma_f32 v[122:123], v[74:75], v[74:75], s[52:53]
    v_pk_fma_f32 v[124:125], v[76:77], v[76:77], s[52:53]
    v_pk_fma_f32 v[126:127], v[78:79], v[78:79], s[52:53]
    v_pk_mul_f32 v[112:113], v[64:65], v[112:113] neg_lo:[1,0] neg_hi:[1,0]
    v_pk_mul_f32 v[114:115], v[66:67], v[114:115] neg_lo:[1,0] neg_hi:[1,0]
    v_pk_mul_f32 v[116:117], v[68:69], v[116:117] neg_lo:[1,0] neg_hi:[1,0]
    v_pk_mul_f32 v[118:119], v[70:71], v[118:119] neg_lo:[1,0] neg_hi:[1,0]
    v_pk_mul_f32 v[120:121], v[72:73], v[120:121] neg_lo:[1,0] neg_hi:[1,0]
    v_pk_mul_f32 v[122:123], v[74:75], v[122:123] neg_lo:[1,0] neg_hi:[1,0]
    v_pk_mul_f32 v[124:125], v[76:77], v[124:125] neg_lo:[1,0] neg_hi:[1,0]
    v_pk_mul_f32 v[126:127], v[78:79], v[126:127] neg_lo:[1,0] neg_hi:[1,0]
    s_waitcnt vmcnt(0) lgkmcnt(1)
    s_nop 0
    v_mfma_f32_32x32x16_bf16 v[80:95], a[96:99], v[192:195], 0
    ds_read_b64_tr_b16 a[156:157], v9 offset:27648
    ds_read_b64_tr_b16 a[158:159], v9 offset:29184
    v_cvt_pk_bf16_f32 v252, v128, v129
    v_cvt_pk_bf16_f32 v253, v130, v131
    v_cvt_pk_bf16_f32 v254, v132, v133
    v_cvt_pk_bf16_f32 v255, v134, v135
    v_mfma_f32_32x32x16_bf16 v[80:95], a[100:103], v[196:199], v[80:95]
    ds_read_b64_tr_b16 a[160:161], v9 offset:27712
    ds_read_b64_tr_b16 a[162:163], v9 offset:29248
    v_cvt_pk_bf16_f32 v12, v136, v137
    v_cvt_pk_bf16_f32 v13, v138, v139
    v_cvt_pk_bf16_f32 v14, v140, v141
    v_cvt_pk_bf16_f32 v15, v142, v143
    v_mfma_f32_32x32x16_bf16 v[80:95], a[104:107], v[200:203], v[80:95]
    ds_read_b64_tr_b16 a[164:165], v9 offset:27776
    ds_read_b64_tr_b16 a[166:167], v9 offset:29312
    v_exp_f32 v112, v112
    v_exp_f32 v113, v113
    v_mfma_f32_32x32x16_bf16 v[80:95], a[108:111], v[204:207], v[80:95]
    ds_write_b128 v219, v[160:163] offset:1792
    v_exp_f32_e64 v114, v114
    v_mfma_f32_32x32x16_bf16 v[80:95], a[112:115], v[208:211], v[80:95]
    ds_read_b64_tr_b16 a[120:121], v220 offset:128
    ds_read_b64_tr_b16 a[122:123], v220 offset:896
    v_exp_f32 v115, v115
    v_exp_f32 v116, v116
    v_mfma_f32_32x32x16_bf16 v[80:95], a[116:119], v[212:215], v[80:95]
    ds_read_b64_tr_b16 a[124:125], v220 offset:3200
    ds_read_b64_tr_b16 a[126:127], v220 offset:3968
    v_exp_f32 v117, v117
    v_exp_f32 v118, v118
    v_mfma_f32_32x32x16_bf16 v[16:31], a[144:147], v[252:255], v[16:31]
    ds_read_b64_tr_b16 a[128:129], v220 offset:6272
    ds_read_b64_tr_b16 a[130:131], v220 offset:7040
    v_exp_f32 v119, v119
    v_exp_f32 v120, v120
    v_mfma_f32_32x32x16_bf16 v[32:47], a[148:151], v[252:255], v[32:47]
    s_waitcnt lgkmcnt(7)
    ds_write_b128 v219, v[164:167] offset:2016
    v_exp_f32 v121, v121
    v_mfma_f32_32x32x16_bf16 v[48:63], a[152:155], v[252:255], v[48:63]
    ds_read_b64_tr_b16 a[132:133], v220 offset:9344
    ds_read_b64_tr_b16 a[134:135], v220 offset:10112
    v_exp_f32 v122, v122
    v_exp_f32 v123, v123
    v_mfma_f32_32x32x16_bf16 v[16:31], a[156:159], v[12:15], v[16:31]
    ds_read_b64_tr_b16 a[136:137], v220 offset:12416
    ds_read_b64_tr_b16 a[138:139], v220 offset:13184
    v_exp_f32 v124, v124
    v_exp_f32 v125, v125
    v_mfma_f32_32x32x16_bf16 v[32:47], a[160:163], v[12:15], v[32:47]
    ds_read_b64_tr_b16 a[140:141], v220 offset:15488
    ds_read_b64_tr_b16 a[142:143], v220 offset:16256
    v_exp_f32 v126, v126
    v_exp_f32 v127, v127
    v_mfma_f32_32x32x16_bf16 v[48:63], a[164:167], v[12:15], v[48:63]
    ds_read_b64_tr_b16 a[168:169], v9 offset:0
    ds_read_b64_tr_b16 a[170:171], v9 offset:1536
    v_rcp_f32 v144, v144
    v_rcp_f32 v145, v145
    v_rcp_f32 v146, v146
    v_rcp_f32 v147, v147
    v_rcp_f32 v148, v148
    v_rcp_f32 v149, v149
    v_rcp_f32 v150, v150
    v_rcp_f32 v151, v151
    v_rcp_f32 v152, v152
    v_rcp_f32 v153, v153
    v_rcp_f32 v154, v154
    v_rcp_f32 v155, v155
    v_rcp_f32 v156, v156
    v_rcp_f32 v157, v157
    v_rcp_f32 v158, v158
    v_rcp_f32 v159, v159
    v_pk_fma_f32 v[112:113], v[112:113], s[54:55], s[54:55]
    v_pk_fma_f32 v[114:115], v[114:115], s[54:55], s[54:55]
    v_pk_fma_f32 v[116:117], v[116:117], s[54:55], s[54:55]
    v_pk_fma_f32 v[118:119], v[118:119], s[54:55], s[54:55]
    v_pk_fma_f32 v[120:121], v[120:121], s[54:55], s[54:55]
    v_pk_fma_f32 v[122:123], v[122:123], s[54:55], s[54:55]
    v_pk_fma_f32 v[124:125], v[124:125], s[54:55], s[54:55]
    v_pk_fma_f32 v[126:127], v[126:127], s[54:55], s[54:55]
    v_pk_mul_f32 v[144:145], v[96:97], v[144:145]
    v_pk_mul_f32 v[146:147], v[98:99], v[146:147]
    v_pk_mul_f32 v[148:149], v[100:101], v[148:149]
    v_pk_mul_f32 v[150:151], v[102:103], v[150:151]
    v_pk_mul_f32 v[152:153], v[104:105], v[152:153]
    v_pk_mul_f32 v[154:155], v[106:107], v[154:155]
    v_pk_mul_f32 v[156:157], v[108:109], v[156:157]
    v_pk_mul_f32 v[158:159], v[110:111], v[158:159]
    v_pk_fma_f32 v[128:129], v[80:81], v[80:81], s[52:53]
    v_pk_fma_f32 v[130:131], v[82:83], v[82:83], s[52:53]
    v_pk_fma_f32 v[132:133], v[84:85], v[84:85], s[52:53]
    v_pk_fma_f32 v[134:135], v[86:87], v[86:87], s[52:53]
    v_pk_fma_f32 v[136:137], v[88:89], v[88:89], s[52:53]
    v_pk_fma_f32 v[138:139], v[90:91], v[90:91], s[52:53]
    v_pk_fma_f32 v[140:141], v[92:93], v[92:93], s[52:53]
    v_pk_fma_f32 v[142:143], v[94:95], v[94:95], s[52:53]
    v_pk_mul_f32 v[128:129], v[80:81], v[128:129] neg_lo:[1,0] neg_hi:[1,0]
    v_pk_mul_f32 v[130:131], v[82:83], v[130:131] neg_lo:[1,0] neg_hi:[1,0]
    v_pk_mul_f32 v[132:133], v[84:85], v[132:133] neg_lo:[1,0] neg_hi:[1,0]
    v_pk_mul_f32 v[134:135], v[86:87], v[134:135] neg_lo:[1,0] neg_hi:[1,0]
    v_pk_mul_f32 v[136:137], v[88:89], v[136:137] neg_lo:[1,0] neg_hi:[1,0]
    v_pk_mul_f32 v[138:139], v[90:91], v[138:139] neg_lo:[1,0] neg_hi:[1,0]
    v_pk_mul_f32 v[140:141], v[92:93], v[140:141] neg_lo:[1,0] neg_hi:[1,0]
    v_pk_mul_f32 v[142:143], v[94:95], v[142:143] neg_lo:[1,0] neg_hi:[1,0]
    s_waitcnt lgkmcnt(0)
    v_mfma_f32_32x32x16_bf16 v[96:111], a[120:123], v[192:195], 0
    s_barrier
    v_cvt_pk_bf16_f32 v252, v144, v145
    v_mfma_f32_32x32x16_bf16 v[96:111], a[124:127], v[196:199], v[96:111]
    ds_read_b64_tr_b16 a[172:173], v9 offset:64
    ds_read_b64_tr_b16 a[174:175], v9 offset:1600
    ds_read_b64_tr_b16 a[176:177], v9 offset:128
    v_cvt_pk_bf16_f32 v253, v146, v147
    v_cvt_pk_bf16_f32 v254, v148, v149
    v_cvt_pk_bf16_f32 v255, v150, v151
    v_mfma_f32_32x32x16_bf16 v[96:111], a[128:131], v[200:203], v[96:111]
    ds_read_b64_tr_b16 a[178:179], v9 offset:1664
    ds_read_b64_tr_b16 a[180:181], v9 offset:3072
    ds_read_b64_tr_b16 a[182:183], v9 offset:4608
    v_cvt_pk_bf16_f32 v12, v152, v153
    v_cvt_pk_bf16_f32 v13, v154, v155
    v_cvt_pk_bf16_f32 v14, v156, v157
    v_mfma_f32_32x32x16_bf16 v[96:111], a[132:135], v[204:207], v[96:111]
    ds_read_b64_tr_b16 a[184:185], v9 offset:3136
    ds_read_b64_tr_b16 a[186:187], v9 offset:4672
    v_cvt_pk_bf16_f32 v15, v158, v159
    v_exp_f32 v128, v128
    v_exp_f32 v129, v129
    v_mfma_f32_32x32x16_bf16 v[96:111], a[136:139], v[208:211], v[96:111]
    ds_read_b64_tr_b16 a[188:189], v9 offset:3200
    ds_read_b64_tr_b16 a[190:191], v9 offset:4736
    v_exp_f32 v130, v130
    v_exp_f32 v131, v131
    v_mfma_f32_32x32x16_bf16 v[96:111], a[140:143], v[212:215], v[96:111]
    s_waitcnt lgkmcnt(4)
    v_exp_f32 v132, v132
    v_exp_f32 v133, v133
    v_exp_f32 v134, v134
    v_mfma_f32_32x32x16_bf16 v[16:31], a[168:171], v[252:255], v[16:31]
    ds_read_b128 v[192:195], v1 offset:1024
    v_exp_f32 v135, v135
    v_exp_f32 v136, v136
    v_exp_f32_e64 v137, v137
    v_mfma_f32_32x32x16_bf16 v[32:47], a[172:175], v[252:255], v[32:47]
    ds_read_b128 v[196:199], v1 offset:7328
    v_exp_f32 v138, v138
    v_exp_f32 v139, v139
    v_exp_f32_e64 v140, v140
    v_mfma_f32_32x32x16_bf16 v[48:63], a[176:179], v[252:255], v[48:63]
    ds_read_b128 v[200:203], v1 offset:13632
    v_exp_f32 v141, v141
    v_exp_f32 v142, v142
    v_exp_f32_e64 v143, v143
    v_mfma_f32_32x32x16_bf16 v[16:31], a[180:183], v[12:15], v[16:31]
    ds_read_b128 v[204:207], v1 offset:19936
    v_rcp_f32 v112, v112
    v_rcp_f32 v113, v113
    v_rcp_f32 v114, v114
    s_waitcnt lgkmcnt(6)
    v_mfma_f32_32x32x16_bf16 v[32:47], a[184:187], v[12:15], v[32:47]
    ds_read_b128 v[208:211], v1 offset:26240
    v_rcp_f32 v115, v115
    v_rcp_f32 v116, v116
    v_rcp_f32 v117, v117
    s_waitcnt lgkmcnt(5)
    v_mfma_f32_32x32x16_bf16 v[48:63], a[188:191], v[12:15], v[48:63]
    ds_read_b128 v[212:215], v1 offset:32544
    v_rcp_f32 v118, v118
    v_rcp_f32 v119, v119
    v_rcp_f32 v120, v120
    v_rcp_f32 v121, v121
    v_rcp_f32 v122, v122
    v_rcp_f32 v123, v123
    v_rcp_f32 v124, v124
    v_rcp_f32 v125, v125
    v_rcp_f32 v126, v126
    v_rcp_f32 v127, v127
    v_pk_fma_f32 v[128:129], v[128:129], s[54:55], s[54:55]
    v_pk_fma_f32 v[130:131], v[130:131], s[54:55], s[54:55]
    v_pk_fma_f32 v[132:133], v[132:133], s[54:55], s[54:55]
    v_pk_fma_f32 v[134:135], v[134:135], s[54:55], s[54:55]
    v_pk_fma_f32 v[136:137], v[136:137], s[54:55], s[54:55]
    v_pk_fma_f32 v[138:139], v[138:139], s[54:55], s[54:55]
    v_pk_fma_f32 v[140:141], v[140:141], s[54:55], s[54:55]
    v_pk_fma_f32 v[142:143], v[142:143], s[54:55], s[54:55]
    v_pk_mul_f32 v[112:113], v[64:65], v[112:113]
    v_pk_mul_f32 v[114:115], v[66:67], v[114:115]
    v_pk_mul_f32 v[116:117], v[68:69], v[116:117]
    v_pk_mul_f32 v[118:119], v[70:71], v[118:119]
    v_pk_mul_f32 v[120:121], v[72:73], v[120:121]
    v_pk_mul_f32 v[122:123], v[74:75], v[122:123]
    v_pk_mul_f32 v[124:125], v[76:77], v[124:125]
    v_pk_mul_f32 v[126:127], v[78:79], v[126:127]
    v_pk_fma_f32 v[144:145], v[96:97], v[96:97], s[52:53]
    v_pk_fma_f32 v[146:147], v[98:99], v[98:99], s[52:53]
    v_pk_fma_f32 v[148:149], v[100:101], v[100:101], s[52:53]
    v_pk_fma_f32 v[150:151], v[102:103], v[102:103], s[52:53]
    v_pk_fma_f32 v[152:153], v[104:105], v[104:105], s[52:53]
    v_pk_fma_f32 v[154:155], v[106:107], v[106:107], s[52:53]
    v_pk_fma_f32 v[156:157], v[108:109], v[108:109], s[52:53]
    v_pk_fma_f32 v[158:159], v[110:111], v[110:111], s[52:53]
    v_pk_mul_f32 v[144:145], v[96:97], v[144:145] neg_lo:[1,0] neg_hi:[1,0]
    v_pk_mul_f32 v[146:147], v[98:99], v[146:147] neg_lo:[1,0] neg_hi:[1,0]
    v_pk_mul_f32 v[148:149], v[100:101], v[148:149] neg_lo:[1,0] neg_hi:[1,0]
    v_pk_mul_f32 v[150:151], v[102:103], v[150:151] neg_lo:[1,0] neg_hi:[1,0]
    v_pk_mul_f32 v[152:153], v[104:105], v[152:153] neg_lo:[1,0] neg_hi:[1,0]
    v_pk_mul_f32 v[154:155], v[106:107], v[154:155] neg_lo:[1,0] neg_hi:[1,0]
    v_pk_mul_f32 v[156:157], v[108:109], v[156:157] neg_lo:[1,0] neg_hi:[1,0]
    v_pk_mul_f32 v[158:159], v[110:111], v[158:159] neg_lo:[1,0] neg_hi:[1,0]
    s_waitcnt lgkmcnt(0)
    s_nop 0
    v_mfma_f32_32x32x16_bf16 v[64:79], a[0:3], v[192:195], 0
    ds_read_b64_tr_b16 a[240:241], v6 offset:24576
    v_cvt_pk_bf16_f32 v252, v112, v113
    v_cvt_pk_bf16_f32 v253, v114, v115
    v_cvt_pk_bf16_f32 v254, v116, v117
    v_cvt_pk_bf16_f32 v255, v118, v119
    v_cvt_pk_bf16_f32 v12, v120, v121
    v_mfma_f32_32x32x16_bf16 v[64:79], a[4:7], v[196:199], v[64:79]
    ds_read_b64_tr_b16 a[242:243], v6 offset:26112
    v_cvt_pk_bf16_f32 v13, v122, v123
    v_cvt_pk_bf16_f32 v14, v124, v125
    v_cvt_pk_bf16_f32 v15, v126, v127
    v_exp_f32_e64 v144, v144
    v_mfma_f32_32x32x16_bf16 v[64:79], a[8:11], v[200:203], v[64:79]
    ds_read_b64_tr_b16 a[244:245], v6 offset:24640
    v_exp_f32 v145, v145
    v_exp_f32 v146, v146
    v_exp_f32_e64 v147, v147
    v_mfma_f32_32x32x16_bf16 v[64:79], a[12:15], v[204:207], v[64:79]
    ds_read_b64_tr_b16 a[246:247], v6 offset:26176
    v_exp_f32 v148, v148
    v_exp_f32 v149, v149
    v_exp_f32_e64 v150, v150
    v_mfma_f32_32x32x16_bf16 v[64:79], a[16:19], v[208:211], v[64:79]
    ds_read_b64_tr_b16 a[248:249], v6 offset:24704
    v_exp_f32 v151, v151
    v_exp_f32 v152, v152
    v_exp_f32_e64 v153, v153
    v_mfma_f32_32x32x16_bf16 v[64:79], a[20:23], v[212:215], v[64:79]
    ds_read_b64_tr_b16 a[250:251], v6 offset:26240
    v_exp_f32 v154, v154
    v_exp_f32 v155, v155
    v_exp_f32_e64 v156, v156
    v_mfma_f32_32x32x16_bf16 v[16:31], a[216:219], v[252:255], v[16:31]
    ds_read_b64_tr_b16 a[252:253], v6 offset:27648
    v_exp_f32 v157, v157
    v_exp_f32 v158, v158
    v_exp_f32_e64 v159, v159
    v_mfma_f32_32x32x16_bf16 v[32:47], a[220:223], v[252:255], v[32:47]
    ds_read_b64_tr_b16 a[254:255], v6 offset:29184
    v_rcp_f32 v128, v128
    v_rcp_f32 v129, v129
    v_rcp_f32_e64 v130, v130
    v_mfma_f32_32x32x16_bf16 v[48:63], a[224:227], v[252:255], v[48:63]
    ds_read_b64_tr_b16 v[160:161], v6 offset:27712
    v_rcp_f32 v131, v131
    v_rcp_f32 v132, v132
    v_rcp_f32_e64 v133, v133
    v_mfma_f32_32x32x16_bf16 v[16:31], a[228:231], v[12:15], v[16:31]
    ds_read_b64_tr_b16 v[162:163], v6 offset:29248
    v_rcp_f32 v134, v134
    v_rcp_f32 v135, v135
    v_rcp_f32_e64 v136, v136
    v_mfma_f32_32x32x16_bf16 v[32:47], a[232:235], v[12:15], v[32:47]
    ds_read_b64_tr_b16 v[164:165], v6 offset:27776
    v_rcp_f32 v137, v137
    v_rcp_f32 v138, v138
    v_rcp_f32_e64 v139, v139
    v_mfma_f32_32x32x16_bf16 v[48:63], a[236:239], v[12:15], v[48:63]
    ds_read_b64_tr_b16 v[166:167], v6 offset:29312
    v_rcp_f32 v140, v140
    v_rcp_f32 v141, v141
    v_rcp_f32 v142, v142
    v_rcp_f32 v143, v143
    v_pk_fma_f32 v[144:145], v[144:145], s[54:55], s[54:55]
    v_pk_fma_f32 v[146:147], v[146:147], s[54:55], s[54:55]
    v_pk_fma_f32 v[148:149], v[148:149], s[54:55], s[54:55]
    v_pk_fma_f32 v[150:151], v[150:151], s[54:55], s[54:55]
    v_pk_fma_f32 v[152:153], v[152:153], s[54:55], s[54:55]
    v_pk_fma_f32 v[154:155], v[154:155], s[54:55], s[54:55]
    v_pk_fma_f32 v[156:157], v[156:157], s[54:55], s[54:55]
    v_pk_fma_f32 v[158:159], v[158:159], s[54:55], s[54:55]
    v_pk_mul_f32 v[128:129], v[80:81], v[128:129]
    v_pk_mul_f32 v[130:131], v[82:83], v[130:131]
    v_pk_mul_f32 v[132:133], v[84:85], v[132:133]
    v_pk_mul_f32 v[134:135], v[86:87], v[134:135]
    v_pk_mul_f32 v[136:137], v[88:89], v[136:137]
    v_pk_mul_f32 v[138:139], v[90:91], v[138:139]
L_pad3:
    s_cbranch_execz L_padret3
    s_nop 0
    v_pk_mul_f32 v[140:141], v[92:93], v[140:141]
    v_pk_mul_f32 v[142:143], v[94:95], v[142:143]
    v_pk_fma_f32 v[112:113], v[64:65], v[64:65], s[52:53]
    v_pk_fma_f32 v[114:115], v[66:67], v[66:67], s[52:53]
    v_pk_fma_f32 v[116:117], v[68:69], v[68:69], s[52:53]
    v_pk_fma_f32 v[118:119], v[70:71], v[70:71], s[52:53]
    v_pk_fma_f32 v[120:121], v[72:73], v[72:73], s[52:53]
    v_pk_fma_f32 v[122:123], v[74:75], v[74:75], s[52:53]
    v_pk_fma_f32 v[124:125], v[76:77], v[76:77], s[52:53]
    v_pk_fma_f32 v[126:127], v[78:79], v[78:79], s[52:53]
    v_pk_mul_f32 v[112:113], v[64:65], v[112:113] neg_lo:[1,0] neg_hi:[1,0]
    v_pk_mul_f32 v[114:115], v[66:67], v[114:115] neg_lo:[1,0] neg_hi:[1,0]
    v_pk_mul_f32 v[116:117], v[68:69], v[116:117] neg_lo:[1,0] neg_hi:[1,0]
    v_pk_mul_f32 v[118:119], v[70:71], v[118:119] neg_lo:[1,0] neg_hi:[1,0]
    v_pk_mul_f32 v[120:121], v[72:73], v[120:121] neg_lo:[1,0] neg_hi:[1,0]
    v_pk_mul_f32 v[122:123], v[74:75], v[122:123] neg_lo:[1,0] neg_hi:[1,0]
    v_pk_mul_f32 v[124:125], v[76:77], v[124:125] neg_lo:[1,0] neg_hi:[1,0]
    v_pk_mul_f32 v[126:127], v[78:79], v[126:127] neg_lo:[1,0] neg_hi:[1,0]
    v_mfma_f32_32x32x16_bf16 v[80:95], a[24:27], v[192:195], 0
    s_waitcnt lgkmcnt(0)
    s_nop 0
    ds_read_b64_tr_b16 v[168:169], v6 offset:0
    v_cvt_pk_bf16_f32 v252, v128, v129
    v_cvt_pk_bf16_f32 v253, v130, v131
    v_cvt_pk_bf16_f32 v254, v132, v133
    v_cvt_pk_bf16_f32 v255, v134, v135
    v_cvt_pk_bf16_f32 v12, v136, v137
    v_mfma_f32_32x32x16_bf16 v[80:95], a[28:31], v[196:199], v[80:95]
    ds_read_b64_tr_b16 v[170:171], v6 offset:1536
    v_cvt_pk_bf16_f32 v13, v138, v139
    v_cvt_pk_bf16_f32 v14, v140, v141
    v_cvt_pk_bf16_f32 v15, v142, v143
    v_exp_f32_e64 v112, v112
    v_mfma_f32_32x32x16_bf16 v[80:95], a[32:35], v[200:203], v[80:95]
    ds_read_b64_tr_b16 v[172:173], v6 offset:64
    v_exp_f32 v113, v113
    v_exp_f32 v114, v114
    v_exp_f32_e64 v115, v115
    v_mfma_f32_32x32x16_bf16 v[80:95], a[36:39], v[204:207], v[80:95]
    ds_read_b64_tr_b16 v[174:175], v6 offset:1600
    v_exp_f32 v116, v116
    v_exp_f32 v117, v117
    v_exp_f32_e64 v118, v118
    v_mfma_f32_32x32x16_bf16 v[80:95], a[40:43], v[208:211], v[80:95]
    ds_read_b64_tr_b16 v[176:177], v6 offset:128
    v_exp_f32 v119, v119
    v_exp_f32 v120, v120
    v_exp_f32_e64 v121, v121
    v_mfma_f32_32x32x16_bf16 v[80:95], a[44:47], v[212:215], v[80:95]
    ds_read_b64_tr_b16 v[178:179], v6 offset:1664
    v_exp_f32 v122, v122
    v_exp_f32 v123, v123
    v_exp_f32_e64 v124, v124
    v_mfma_f32_32x32x16_bf16 v[16:31], a[240:243], v[252:255], v[16:31]
    ds_read_b64_tr_b16 v[180:181], v6 offset:3072
    v_exp_f32 v125, v125
    v_exp_f32 v126, v126
    v_exp_f32_e64 v127, v127
    v_mfma_f32_32x32x16_bf16 v[32:47], a[244:247], v[252:255], v[32:47]
    ds_read_b64_tr_b16 v[182:183], v6 offset:4608
    v_rcp_f32 v144, v144
    v_rcp_f32 v145, v145
    v_rcp_f32_e64 v146, v146
    v_mfma_f32_32x32x16_bf16 v[48:63], a[248:251], v[252:255], v[48:63]
    ds_read_b64_tr_b16 v[184:185], v6 offset:3136
    v_rcp_f32 v147, v147
    v_rcp_f32 v148, v148
    v_rcp_f32_e64 v149, v149
    v_mfma_f32_32x32x16_bf16 v[16:31], a[252:255], v[12:15], v[16:31]
    ds_read_b64_tr_b16 v[186:187], v6 offset:4672
    v_rcp_f32 v150, v150
    v_rcp_f32 v151, v151
    v_rcp_f32_e64 v152, v152
    v_mfma_f32_32x32x16_bf16 v[32:47], v[160:163], v[12:15], v[32:47]
    ds_read_b64_tr_b16 v[188:189], v6 offset:3200
    v_rcp_f32 v153, v153
    v_rcp_f32 v154, v154
    v_rcp_f32_e64 v155, v155
    v_mfma_f32_32x32x16_bf16 v[48:63], v[164:167], v[12:15], v[48:63]
    ds_read_b64_tr_b16 v[190:191], v6 offset:4736
    v_rcp_f32 v156, v156
    v_rcp_f32 v157, v157
    v_rcp_f32 v158, v158
    v_rcp_f32 v159, v159
    v_pk_fma_f32 v[112:113], v[112:113], s[54:55], s[54:55]
    v_pk_fma_f32 v[114:115], v[114:115], s[54:55], s[54:55]
    v_pk_fma_f32 v[116:117], v[116:117], s[54:55], s[54:55]
    v_pk_fma_f32 v[118:119], v[118:119], s[54:55], s[54:55]
    v_pk_fma_f32 v[120:121], v[120:121], s[54:55], s[54:55]
    v_pk_fma_f32 v[122:123], v[122:123], s[54:55], s[54:55]
    v_pk_fma_f32 v[124:125], v[124:125], s[54:55], s[54:55]
    v_pk_fma_f32 v[126:127], v[126:127], s[54:55], s[54:55]
    v_pk_mul_f32 v[144:145], v[96:97], v[144:145]
    v_pk_mul_f32 v[146:147], v[98:99], v[146:147]
    v_pk_mul_f32 v[148:149], v[100:101], v[148:149]
    v_pk_mul_f32 v[150:151], v[102:103], v[150:151]
    v_pk_mul_f32 v[152:153], v[104:105], v[152:153]
    v_pk_mul_f32 v[154:155], v[106:107], v[154:155]
    v_pk_mul_f32 v[156:157], v[108:109], v[156:157]
    v_pk_mul_f32 v[158:159], v[110:111], v[158:159]
    v_pk_fma_f32 v[128:129], v[80:81], v[80:81], s[52:53]
    v_pk_fma_f32 v[130:131], v[82:83], v[82:83], s[52:53]
    v_pk_fma_f32 v[132:133], v[84:85], v[84:85], s[52:53]
    v_pk_fma_f32 v[134:135], v[86:87], v[86:87], s[52:53]
    v_pk_fma_f32 v[136:137], v[88:89], v[88:89], s[52:53]
    v_pk_fma_f32 v[138:139], v[90:91], v[90:91], s[52:53]
    v_pk_fma_f32 v[140:141], v[92:93], v[92:93], s[52:53]
    v_pk_fma_f32 v[142:143], v[94:95], v[94:95], s[52:53]
    v_pk_mul_f32 v[128:129], v[80:81], v[128:129] neg_lo:[1,0] neg_hi:[1,0]
    v_pk_mul_f32 v[130:131], v[82:83], v[130:131] neg_lo:[1,0] neg_hi:[1,0]
    v_pk_mul_f32 v[132:133], v[84:85], v[132:133] neg_lo:[1,0] neg_hi:[1,0]
    v_pk_mul_f32 v[134:135], v[86:87], v[134:135] neg_lo:[1,0] neg_hi:[1,0]
    v_pk_mul_f32 v[136:137], v[88:89], v[136:137] neg_lo:[1,0] neg_hi:[1,0]
    v_pk_mul_f32 v[138:139], v[90:91], v[138:139] neg_lo:[1,0] neg_hi:[1,0]
    v_pk_mul_f32 v[140:141], v[92:93], v[140:141] neg_lo:[1,0] neg_hi:[1,0]
    v_pk_mul_f32 v[142:143], v[94:95], v[142:143] neg_lo:[1,0] neg_hi:[1,0]
    s_waitcnt lgkmcnt(0)
    s_nop 0
    v_mfma_f32_32x32x16_bf16 v[96:111], a[48:51], v[192:195], 0
    buffer_load_dwordx4 v[240:243], v0, s[24:27], 0 offen offset:0
    v_cvt_pk_bf16_f32 v252, v144, v145
    v_cvt_pk_bf16_f32 v253, v146, v147
    v_cvt_pk_bf16_f32 v254, v148, v149
    v_cvt_pk_bf16_f32 v255, v150, v151
    v_cvt_pk_bf16_f32 v12, v152, v153
    s_nop 0
    s_nop 0
    v_mfma_f32_32x32x16_bf16 v[16:31], v[168:171], v[252:255], v[16:31]
    s_mov_b32 s68, 0x3f80
    v_cvt_pk_bf16_f32 v13, v154, v155
    v_cvt_pk_bf16_f32 v14, v156, v157
    v_cvt_pk_bf16_f32 v15, v158, v159
    v_mov_b32 v9, v216
    v_mov_b32 v6, v217
    v_exp_f32_e64 v128, v128
    v_mfma_f32_32x32x16_bf16 v[96:111], a[52:55], v[196:199], v[96:111]
    buffer_load_dwordx4 v[244:247], v0, s[24:27], 0 offen offset:64
    v_exp_f32 v129, v129
    v_exp_f32 v130, v130
    v_exp_f32_e64 v131, v131
    v_mfma_f32_32x32x16_bf16 v[16:31], v[180:183], v[12:15], v[16:31]
    s_mov_b32 s69, 0x3f800000
    v_exp_f32 v132, v132
    v_exp_f32 v133, v133
    v_exp_f32 v134, v134
    v_mfma_f32_32x32x16_bf16 v[96:111], a[56:59], v[200:203], v[96:111]
    buffer_load_dwordx4 v[248:251], v0, s[24:27], 0 offen offset:128
    v_exp_f32 v135, v135
    v_exp_f32 v136, v136
    v_exp_f32_e64 v137, v137
    v_mfma_f32_32x32x16_bf16 v[32:47], v[172:175], v[252:255], v[32:47]
    s_nop 1
    ds_write_b128 v2, v[16:19] offset:0
    v_exp_f32 v138, v138
    v_mfma_f32_32x32x16_bf16 v[96:111], a[60:63], v[204:207], v[96:111]
    s_mov_b32 s46, 9633792
    v_exp_f32 v139, v139
    v_exp_f32 v140, v140
    v_exp_f32_e64 v141, v141
    v_mfma_f32_32x32x16_bf16 v[32:47], v[184:187], v[12:15], v[32:47]
    ds_write_b128 v2, v[20:23] offset:1088
    v_exp_f32_e64 v142, v142
    v_mfma_f32_32x32x16_bf16 v[96:111], a[64:67], v[208:211], v[96:111]
    s_mov_b32 s47, 0x20000
    v_exp_f32 v143, v143
    v_rcp_f32 v112, v112
    v_rcp_f32_e64 v113, v113
    v_mfma_f32_32x32x16_bf16 v[48:63], v[176:179], v[252:255], v[48:63]
    ds_write_b128 v2, v[24:27] offset:2176
    v_rcp_f32_e64 v114, v114
    v_mfma_f32_32x32x16_bf16 v[96:111], a[68:71], v[212:215], v[96:111]
    v_rcp_f32 v115, v115
    v_rcp_f32 v116, v116
    v_rcp_f32_e64 v117, v117
    v_mfma_f32_32x32x16_bf16 v[48:63], v[188:191], v[12:15], v[48:63]
    ds_write_b128 v2, v[28:31] offset:3264
    v_rcp_f32 v118, v118
    v_rcp_f32 v119, v119
    v_rcp_f32 v120, v120
    v_rcp_f32 v121, v121
    v_rcp_f32 v122, v122
    v_rcp_f32 v123, v123
    v_rcp_f32 v124, v124
    v_rcp_f32 v125, v125
    v_rcp_f32 v126, v126
    v_rcp_f32 v127, v127
    v_pk_fma_f32 v[128:129], v[128:129], s[54:55], s[54:55]
    v_pk_fma_f32 v[130:131], v[130:131], s[54:55], s[54:55]
    v_pk_fma_f32 v[132:133], v[132:133], s[54:55], s[54:55]
    v_pk_fma_f32 v[134:135], v[134:135], s[54:55], s[54:55]
    v_pk_fma_f32 v[136:137], v[136:137], s[54:55], s[54:55]
    v_pk_fma_f32 v[138:139], v[138:139], s[54:55], s[54:55]
    ds_write_b128 v2, v[40:43] offset:6528
    v_pk_fma_f32 v[140:141], v[140:141], s[54:55], s[54:55]
    v_pk_fma_f32 v[142:143], v[142:143], s[54:55], s[54:55]
    v_pk_mul_f32 v[112:113], v[64:65], v[112:113]
    v_pk_mul_f32 v[114:115], v[66:67], v[114:115]
    v_pk_mul_f32 v[116:117], v[68:69], v[116:117]
    v_pk_mul_f32 v[118:119], v[70:71], v[118:119]
    v_pk_mul_f32 v[120:121], v[72:73], v[120:121]
    v_pk_mul_f32 v[122:123], v[74:75], v[122:123]
    v_pk_mul_f32 v[124:125], v[76:77], v[124:125]
    v_pk_mul_f32 v[126:127], v[78:79], v[126:127]
    v_pk_fma_f32 v[144:145], v[96:97], v[96:97], s[52:53]
    v_pk_fma_f32 v[146:147], v[98:99], v[98:99], s[52:53]
    ds_write_b128 v2, v[36:39] offset:5440
    v_pk_fma_f32 v[148:149], v[100:101], v[100:101], s[52:53]
    v_pk_fma_f32 v[150:151], v[102:103], v[102:103], s[52:53]
    v_pk_fma_f32 v[152:153], v[104:105], v[104:105], s[52:53]
    v_pk_fma_f32 v[154:155], v[106:107], v[106:107], s[52:53]
    v_pk_fma_f32 v[156:157], v[108:109], v[108:109], s[52:53]
    v_pk_fma_f32 v[158:159], v[110:111], v[110:111], s[52:53]
    v_pk_mul_f32 v[144:145], v[96:97], v[144:145] neg_lo:[1,0] neg_hi:[1,0]
    v_pk_mul_f32 v[146:147], v[98:99], v[146:147] neg_lo:[1,0] neg_hi:[1,0]
    v_pk_mul_f32 v[148:149], v[100:101], v[148:149] neg_lo:[1,0] neg_hi:[1,0]
    v_pk_mul_f32 v[150:151], v[102:103], v[150:151] neg_lo:[1,0] neg_hi:[1,0]
    v_pk_mul_f32 v[152:153], v[104:105], v[152:153] neg_lo:[1,0] neg_hi:[1,0]
    v_pk_mul_f32 v[154:155], v[106:107], v[154:155] neg_lo:[1,0] neg_hi:[1,0]
    ds_write_b128 v2, v[32:35] offset:4352
    v_pk_mul_f32 v[156:157], v[108:109], v[156:157] neg_lo:[1,0] neg_hi:[1,0]
    v_pk_mul_f32 v[158:159], v[110:111], v[158:159] neg_lo:[1,0] neg_hi:[1,0]
    v_mfma_f32_32x32x16_bf16 v[64:79], a[72:75], v[192:195], 0
    v_cvt_pk_bf16_f32 v252, v112, v113
    v_cvt_pk_bf16_f32 v253, v114, v115
    v_cvt_pk_bf16_f32 v254, v116, v117
    v_cvt_pk_bf16_f32 v255, v118, v119
    v_cvt_pk_bf16_f32 v12, v120, v121
    v_cvt_pk_bf16_f32 v13, v122, v123
    v_mfma_f32_32x32x16_bf16 v[64:79], a[76:79], v[196:199], v[64:79]
    ds_write_b128 v2, v[44:47] offset:7616
    v_cvt_pk_bf16_f32 v14, v124, v125
    v_mfma_f32_32x32x16_bf16 v[64:79], a[80:83], v[200:203], v[64:79]
    v_cvt_pk_bf16_f32 v15, v126, v127
    v_exp_f32 v144, v144
    v_exp_f32 v145, v145
    v_exp_f32_e64 v146, v146
    v_mfma_f32_32x32x16_bf16 v[64:79], a[84:87], v[204:207], v[64:79]
    ds_write_b128 v2, v[48:51] offset:8704
    v_exp_f32_e64 v147, v147
    v_mfma_f32_32x32x16_bf16 v[64:79], a[88:91], v[208:211], v[64:79]
    v_exp_f32 v148, v148
    v_exp_f32 v149, v149
    v_exp_f32_e64 v150, v150
    v_mfma_f32_32x32x16_bf16 v[64:79], a[92:95], v[212:215], v[64:79]
    ds_write_b128 v2, v[52:55] offset:9792
    v_exp_f32_e64 v151, v151
    v_mfma_f32_32x32x16_bf16 v[16:31], a[192:195], v[252:255], 0
    v_exp_f32 v152, v152
    v_exp_f32 v153, v153
    v_exp_f32_e64 v154, v154
    v_mfma_f32_32x32x16_bf16 v[16:31], a[204:207], v[12:15], v[16:31]
    ds_write_b128 v2, v[56:59] offset:10880
    v_exp_f32_e64 v155, v155
    v_mfma_f32_32x32x16_bf16 v[32:47], a[196:199], v[252:255], 0
    v_exp_f32 v156, v156
    v_exp_f32 v157, v157
    v_exp_f32_e64 v158, v158
    v_mfma_f32_32x32x16_bf16 v[32:47], a[208:211], v[12:15], v[32:47]
    ds_write_b128 v2, v[60:63] offset:11968
    v_exp_f32_e64 v159, v159
    v_mfma_f32_32x32x16_bf16 v[48:63], a[200:203], v[252:255], 0
    v_rcp_f32 v128, v128
    v_rcp_f32 v129, v129
    v_rcp_f32_e64 v130, v130
    v_mfma_f32_32x32x16_bf16 v[48:63], a[212:215], v[12:15], v[48:63]
    v_rcp_f32 v131, v131
    v_rcp_f32 v132, v132
    v_rcp_f32 v133, v133
    v_rcp_f32 v134, v134
    v_rcp_f32 v135, v135
    v_rcp_f32 v136, v136
    v_rcp_f32 v137, v137
    v_rcp_f32 v138, v138
    v_rcp_f32 v139, v139
    v_rcp_f32 v140, v140
    v_rcp_f32 v141, v141
    v_rcp_f32 v142, v142
    v_rcp_f32_e64 v143, v143
    v_pk_fma_f32 v[144:145], v[144:145], s[54:55], s[54:55]
    v_pk_fma_f32 v[146:147], v[146:147], s[54:55], s[54:55]
    v_pk_fma_f32 v[148:149], v[148:149], s[54:55], s[54:55]
    v_pk_fma_f32 v[150:151], v[150:151], s[54:55], s[54:55]
    v_pk_fma_f32 v[152:153], v[152:153], s[54:55], s[54:55]
    v_pk_fma_f32 v[154:155], v[154:155], s[54:55], s[54:55]
    v_pk_fma_f32 v[156:157], v[156:157], s[54:55], s[54:55]
    v_pk_fma_f32 v[158:159], v[158:159], s[54:55], s[54:55]
    v_pk_mul_f32 v[128:129], v[80:81], v[128:129]
    v_pk_mul_f32 v[130:131], v[82:83], v[130:131]
    v_pk_mul_f32 v[132:133], v[84:85], v[132:133]
    v_pk_mul_f32 v[134:135], v[86:87], v[134:135]
    v_pk_mul_f32 v[136:137], v[88:89], v[136:137]
    v_pk_mul_f32 v[138:139], v[90:91], v[138:139]
    v_pk_mul_f32 v[140:141], v[92:93], v[140:141]
    v_pk_mul_f32 v[142:143], v[94:95], v[142:143]
    v_pk_fma_f32 v[112:113], v[64:65], v[64:65], s[52:53]
    v_pk_fma_f32 v[114:115], v[66:67], v[66:67], s[52:53]
    v_pk_fma_f32 v[116:117], v[68:69], v[68:69], s[52:53]
    v_pk_fma_f32 v[118:119], v[70:71], v[70:71], s[52:53]
    v_pk_fma_f32 v[120:121], v[72:73], v[72:73], s[52:53]
    v_pk_fma_f32 v[122:123], v[74:75], v[74:75], s[52:53]
    v_pk_fma_f32 v[124:125], v[76:77], v[76:77], s[52:53]
    v_pk_fma_f32 v[126:127], v[78:79], v[78:79], s[52:53]
    v_pk_mul_f32 v[112:113], v[64:65], v[112:113] neg_lo:[1,0] neg_hi:[1,0]
    v_pk_mul_f32 v[114:115], v[66:67], v[114:115] neg_lo:[1,0] neg_hi:[1,0]
    v_pk_mul_f32 v[116:117], v[68:69], v[116:117] neg_lo:[1,0] neg_hi:[1,0]
    v_pk_mul_f32 v[118:119], v[70:71], v[118:119] neg_lo:[1,0] neg_hi:[1,0]
    v_pk_mul_f32 v[120:121], v[72:73], v[120:121] neg_lo:[1,0] neg_hi:[1,0]
    v_pk_mul_f32 v[122:123], v[74:75], v[122:123] neg_lo:[1,0] neg_hi:[1,0]
    v_pk_mul_f32 v[124:125], v[76:77], v[124:125] neg_lo:[1,0] neg_hi:[1,0]
    v_pk_mul_f32 v[126:127], v[78:79], v[126:127] neg_lo:[1,0] neg_hi:[1,0]
    v_mfma_f32_32x32x16_bf16 v[80:95], a[96:99], v[192:195], 0
    s_waitcnt lgkmcnt(0)
    s_barrier
    v_cvt_pk_bf16_f32 v252, v128, v129
    v_mfma_f32_32x32x16_bf16 v[80:95], a[100:103], v[196:199], v[80:95]
    ds_read_b128 v[216:219], v3 offset:0
    v_cvt_pk_bf16_f32 v253, v130, v131
    v_cvt_pk_bf16_f32 v254, v132, v133
    v_cvt_pk_bf16_f32 v255, v134, v135
    v_cvt_pk_bf16_f32 v12, v136, v137
    v_cvt_pk_bf16_f32 v13, v138, v139
    v_mfma_f32_32x32x16_bf16 v[80:95], a[104:107], v[200:203], v[80:95]
    ds_read_b128 v[220:223], v3 offset:512
    v_cvt_pk_bf16_f32 v14, v140, v141
    v_cvt_pk_bf16_f32 v15, v142, v143
    v_exp_f32 v112, v112
    v_exp_f32 v113, v113
    v_mfma_f32_32x32x16_bf16 v[80:95], a[108:111], v[204:207], v[80:95]
    ds_read_b128 v[224:227], v3 offset:4352
    v_exp_f32 v114, v114
    v_exp_f32 v115, v115
    v_exp_f32_e64 v116, v116
    v_mfma_f32_32x32x16_bf16 v[80:95], a[112:115], v[208:211], v[80:95]
    ds_read_b128 v[228:231], v3 offset:4864
    v_exp_f32 v117, v117
    v_exp_f32 v118, v118
    v_exp_f32_e64 v119, v119
    v_mfma_f32_32x32x16_bf16 v[80:95], a[116:119], v[212:215], v[80:95]
    ds_read_b128 v[232:235], v3 offset:8704
    v_exp_f32 v120, v120
    v_exp_f32 v121, v121
    v_exp_f32_e64 v122, v122
    v_mfma_f32_32x32x16_bf16 v[16:31], a[144:147], v[252:255], v[16:31]
    ds_read_b128 v[236:239], v3 offset:9216
    v_exp_f32 v123, v123
    v_exp_f32 v124, v124
    v_exp_f32_e64 v125, v125
    v_mfma_f32_32x32x16_bf16 v[32:47], a[148:151], v[252:255], v[32:47]
    v_exp_f32 v126, v126
    v_exp_f32 v127, v127
    v_rcp_f32_e64 v144, v144
    v_mfma_f32_32x32x16_bf16 v[48:63], a[152:155], v[252:255], v[48:63]
    v_rcp_f32 v145, v145
    v_rcp_f32 v146, v146
    v_rcp_f32_e64 v147, v147
    v_mfma_f32_32x32x16_bf16 v[16:31], a[156:159], v[12:15], v[16:31]
    v_rcp_f32 v148, v148
    v_rcp_f32 v149, v149
    v_rcp_f32_e64 v150, v150
    v_mfma_f32_32x32x16_bf16 v[32:47], a[160:163], v[12:15], v[32:47]
    v_rcp_f32 v151, v151
    v_rcp_f32 v152, v152
    v_rcp_f32_e64 v153, v153
    v_mfma_f32_32x32x16_bf16 v[48:63], a[164:167], v[12:15], v[48:63]
    s_waitcnt vmcnt(0) lgkmcnt(0)
    v_rcp_f32 v154, v154
    v_rcp_f32 v155, v155
    v_rcp_f32 v156, v156
    v_rcp_f32 v157, v157
    v_rcp_f32 v158, v158
    v_rcp_f32_e64 v159, v159
    v_dot2_f32_bf16 v216, v240, s68, v216
    v_dot2_f32_bf16 v217, v240, s69, v217
    v_dot2_f32_bf16 v218, v241, s68, v218
    v_dot2_f32_bf16 v219, v241, s69, v219
    v_dot2_f32_bf16 v220, v242, s68, v220
    v_dot2_f32_bf16 v221, v242, s69, v221
    v_dot2_f32_bf16 v222, v243, s68, v222
    v_dot2_f32_bf16 v223, v243, s69, v223
    v_dot2_f32_bf16 v224, v244, s68, v224
    v_dot2_f32_bf16 v225, v244, s69, v225
    v_dot2_f32_bf16 v226, v245, s68, v226
    v_dot2_f32_bf16 v227, v245, s69, v227
    v_dot2_f32_bf16 v228, v246, s68, v228
    v_dot2_f32_bf16 v229, v246, s69, v229
    v_dot2_f32_bf16 v230, v247, s68, v230
    v_dot2_f32_bf16 v231, v247, s69, v231
    v_dot2_f32_bf16 v232, v248, s68, v232
    v_dot2_f32_bf16 v233, v248, s69, v233
    v_dot2_f32_bf16 v234, v249, s68, v234
    v_dot2_f32_bf16 v235, v249, s69, v235
    v_dot2_f32_bf16 v236, v250, s68, v236
    v_dot2_f32_bf16 v237, v250, s69, v237
    v_dot2_f32_bf16 v238, v251, s68, v238
    v_dot2_f32_bf16 v239, v251, s69, v239
    v_pk_fma_f32 v[112:113], v[112:113], s[54:55], s[54:55]
    v_pk_fma_f32 v[114:115], v[114:115], s[54:55], s[54:55]
    v_pk_fma_f32 v[116:117], v[116:117], s[54:55], s[54:55]
    v_pk_fma_f32 v[118:119], v[118:119], s[54:55], s[54:55]
    v_pk_fma_f32 v[120:121], v[120:121], s[54:55], s[54:55]
    v_pk_fma_f32 v[122:123], v[122:123], s[54:55], s[54:55]
    v_pk_fma_f32 v[124:125], v[124:125], s[54:55], s[54:55]
    v_pk_fma_f32 v[126:127], v[126:127], s[54:55], s[54:55]
    v_pk_mul_f32 v[144:145], v[96:97], v[144:145]
    v_pk_mul_f32 v[146:147], v[98:99], v[146:147]
    v_pk_mul_f32 v[148:149], v[100:101], v[148:149]
    v_pk_mul_f32 v[150:151], v[102:103], v[150:151]
    v_pk_mul_f32 v[152:153], v[104:105], v[152:153]
    v_pk_mul_f32 v[154:155], v[106:107], v[154:155]
    v_pk_mul_f32 v[156:157], v[108:109], v[156:157]
    v_pk_mul_f32 v[158:159], v[110:111], v[158:159]
    v_pk_fma_f32 v[128:129], v[80:81], v[80:81], s[52:53]
    v_pk_fma_f32 v[130:131], v[82:83], v[82:83], s[52:53]
    v_pk_fma_f32 v[132:133], v[84:85], v[84:85], s[52:53]
    v_pk_fma_f32 v[134:135], v[86:87], v[86:87], s[52:53]
    v_pk_fma_f32 v[136:137], v[88:89], v[88:89], s[52:53]
    v_pk_fma_f32 v[138:139], v[90:91], v[90:91], s[52:53]
    v_pk_fma_f32 v[140:141], v[92:93], v[92:93], s[52:53]
    v_pk_fma_f32 v[142:143], v[94:95], v[94:95], s[52:53]
    v_pk_mul_f32 v[128:129], v[80:81], v[128:129] neg_lo:[1,0] neg_hi:[1,0]
    v_pk_mul_f32 v[130:131], v[82:83], v[130:131] neg_lo:[1,0] neg_hi:[1,0]
    v_pk_mul_f32 v[132:133], v[84:85], v[132:133] neg_lo:[1,0] neg_hi:[1,0]
    v_pk_mul_f32 v[134:135], v[86:87], v[134:135] neg_lo:[1,0] neg_hi:[1,0]
    v_pk_mul_f32 v[136:137], v[88:89], v[136:137] neg_lo:[1,0] neg_hi:[1,0]
    v_pk_mul_f32 v[138:139], v[90:91], v[138:139] neg_lo:[1,0] neg_hi:[1,0]
    v_pk_mul_f32 v[140:141], v[92:93], v[140:141] neg_lo:[1,0] neg_hi:[1,0]
    v_pk_mul_f32 v[142:143], v[94:95], v[142:143] neg_lo:[1,0] neg_hi:[1,0]
    v_mfma_f32_32x32x16_bf16 v[96:111], a[120:123], v[192:195], 0
    ds_read_b128 v[240:243], v3 offset:13056
    v_cvt_pk_bf16_f32 v252, v144, v145
    v_cvt_pk_bf16_f32 v253, v146, v147
    v_cvt_pk_bf16_f32 v254, v148, v149
    v_cvt_pk_bf16_f32 v255, v150, v151
    v_cvt_pk_bf16_f32 v12, v152, v153
    v_mfma_f32_32x32x16_bf16 v[96:111], a[124:127], v[196:199], v[96:111]
    ds_read_b128 v[244:247], v3 offset:13568
    v_cvt_pk_bf16_f32 v13, v154, v155
    v_cvt_pk_bf16_f32 v14, v156, v157
    v_cvt_pk_bf16_f32 v15, v158, v159
    v_exp_f32_e64 v128, v128
    v_mfma_f32_32x32x16_bf16 v[96:111], a[128:131], v[200:203], v[96:111]
    ds_read_b128 v[248:251], v3 offset:17408
    v_exp_f32 v129, v129
    v_exp_f32 v130, v130
    v_exp_f32_e64 v131, v131
    v_mfma_f32_32x32x16_bf16 v[96:111], a[132:135], v[204:207], v[96:111]
    v_exp_f32 v132, v132
    v_exp_f32 v133, v133
    v_exp_f32_e64 v134, v134
    v_mfma_f32_32x32x16_bf16 v[96:111], a[136:139], v[208:211], v[96:111]
    v_exp_f32 v135, v135
    v_exp_f32 v136, v136
    v_exp_f32_e64 v137, v137
    v_mfma_f32_32x32x16_bf16 v[96:111], a[140:143], v[212:215], v[96:111]
    v_exp_f32 v138, v138
    v_exp_f32 v139, v139
    v_exp_f32_e64 v140, v140
    v_mfma_f32_32x32x16_bf16 v[16:31], a[168:171], v[252:255], v[16:31]
    s_waitcnt lgkmcnt(0)
    ds_read_b128 v[192:195], v1 offset:2048
    v_exp_f32 v141, v141
    v_exp_f32 v142, v142
    v_exp_f32 v143, v143
    v_mfma_f32_32x32x16_bf16 v[32:47], a[172:175], v[252:255], v[32:47]
    ds_read_b128 v[196:199], v1 offset:8352
    v_rcp_f32 v112, v112
    v_rcp_f32 v113, v113
    v_rcp_f32_e64 v114, v114
    v_mfma_f32_32x32x16_bf16 v[48:63], a[176:179], v[252:255], v[48:63]
    ds_read_b128 v[200:203], v1 offset:14656
    v_rcp_f32 v115, v115
    v_rcp_f32 v116, v116
    v_rcp_f32_e64 v117, v117
    v_mfma_f32_32x32x16_bf16 v[16:31], a[180:183], v[12:15], v[16:31]
    ds_read_b128 v[204:207], v1 offset:20960
    v_rcp_f32 v118, v118
    v_rcp_f32 v119, v119
    v_rcp_f32_e64 v120, v120
    v_mfma_f32_32x32x16_bf16 v[32:47], a[184:187], v[12:15], v[32:47]
    ds_read_b128 v[208:211], v1 offset:27264
    v_rcp_f32 v121, v121
    v_rcp_f32 v122, v122
    v_rcp_f32_e64 v123, v123
    v_mfma_f32_32x32x16_bf16 v[48:63], a[188:191], v[12:15], v[48:63]
    ds_read_b128 v[212:215], v1 offset:33568
    v_rcp_f32 v124, v124
    v_rcp_f32 v125, v125
    v_rcp_f32 v126, v126
    v_rcp_f32 v127, v127
    v_pk_add_f32 v[216:217], v[216:217], v[240:241]
    v_pk_add_f32 v[218:219], v[218:219], v[242:243]
    v_pk_add_f32 v[220:221], v[220:221], v[244:245]
    v_pk_add_f32 v[222:223], v[222:223], v[246:247]
    v_pk_add_f32 v[224:225], v[224:225], v[248:249]
    v_pk_add_f32 v[226:227], v[226:227], v[250:251]
    v_pk_fma_f32 v[128:129], v[128:129], s[54:55], s[54:55]
    v_pk_fma_f32 v[130:131], v[130:131], s[54:55], s[54:55]
    v_pk_fma_f32 v[132:133], v[132:133], s[54:55], s[54:55]
    v_pk_fma_f32 v[134:135], v[134:135], s[54:55], s[54:55]
    v_pk_fma_f32 v[136:137], v[136:137], s[54:55], s[54:55]
    v_pk_fma_f32 v[138:139], v[138:139], s[54:55], s[54:55]
    v_pk_fma_f32 v[140:141], v[140:141], s[54:55], s[54:55]
    v_pk_fma_f32 v[142:143], v[142:143], s[54:55], s[54:55]
    v_pk_mul_f32 v[112:113], v[64:65], v[112:113]
    v_pk_mul_f32 v[114:115], v[66:67], v[114:115]
    v_pk_mul_f32 v[116:117], v[68:69], v[116:117]
    v_pk_mul_f32 v[118:119], v[70:71], v[118:119]
    v_pk_mul_f32 v[120:121], v[72:73], v[120:121]
    v_pk_mul_f32 v[122:123], v[74:75], v[122:123]
    v_pk_mul_f32 v[124:125], v[76:77], v[124:125]
    v_pk_mul_f32 v[126:127], v[78:79], v[126:127]
    v_pk_fma_f32 v[144:145], v[96:97], v[96:97], s[52:53]
    v_pk_fma_f32 v[146:147], v[98:99], v[98:99], s[52:53]
    v_pk_fma_f32 v[148:149], v[100:101], v[100:101], s[52:53]
    v_pk_fma_f32 v[150:151], v[102:103], v[102:103], s[52:53]
    v_pk_fma_f32 v[152:153], v[104:105], v[104:105], s[52:53]
    v_pk_fma_f32 v[154:155], v[106:107], v[106:107], s[52:53]
    v_pk_fma_f32 v[156:157], v[108:109], v[108:109], s[52:53]
    v_pk_fma_f32 v[158:159], v[110:111], v[110:111], s[52:53]
    v_pk_mul_f32 v[144:145], v[96:97], v[144:145] neg_lo:[1,0] neg_hi:[1,0]
    v_pk_mul_f32 v[146:147], v[98:99], v[146:147] neg_lo:[1,0] neg_hi:[1,0]
    v_pk_mul_f32 v[148:149], v[100:101], v[148:149] neg_lo:[1,0] neg_hi:[1,0]
    v_pk_mul_f32 v[150:151], v[102:103], v[150:151] neg_lo:[1,0] neg_hi:[1,0]
    v_pk_mul_f32 v[152:153], v[104:105], v[152:153] neg_lo:[1,0] neg_hi:[1,0]
    v_pk_mul_f32 v[154:155], v[106:107], v[154:155] neg_lo:[1,0] neg_hi:[1,0]
    v_pk_mul_f32 v[156:157], v[108:109], v[156:157] neg_lo:[1,0] neg_hi:[1,0]
    v_pk_mul_f32 v[158:159], v[110:111], v[158:159] neg_lo:[1,0] neg_hi:[1,0]
    s_waitcnt lgkmcnt(0)
    s_nop 0
    v_mfma_f32_32x32x16_bf16 v[64:79], a[0:3], v[192:195], 0
    ds_read_b128 v[240:243], v3 offset:17920
    v_cvt_pk_bf16_f32 v252, v112, v113
    v_cvt_pk_bf16_f32 v253, v114, v115
    v_cvt_pk_bf16_f32 v254, v116, v117
    v_cvt_pk_bf16_f32 v255, v118, v119
    v_cvt_pk_bf16_f32 v12, v120, v121
    v_mfma_f32_32x32x16_bf16 v[64:79], a[4:7], v[196:199], v[64:79]
    ds_read_b128 v[244:247], v3 offset:21760
    v_cvt_pk_bf16_f32 v13, v122, v123
    v_cvt_pk_bf16_f32 v14, v124, v125
    v_cvt_pk_bf16_f32 v15, v126, v127
    v_exp_f32_e64 v144, v144
    v_mfma_f32_32x32x16_bf16 v[64:79], a[8:11], v[200:203], v[64:79]
    ds_read_b128 v[248:251], v3 offset:22272
    v_exp_f32 v145, v145
    v_exp_f32 v146, v146
    v_exp_f32_e64 v147, v147
    v_mfma_f32_32x32x16_bf16 v[64:79], a[12:15], v[204:207], v[64:79]
    v_exp_f32 v148, v148
    v_exp_f32 v149, v149
    v_exp_f32_e64 v150, v150
    v_mfma_f32_32x32x16_bf16 v[64:79], a[16:19], v[208:211], v[64:79]
    v_exp_f32 v151, v151
    v_exp_f32 v152, v152
    v_exp_f32_e64 v153, v153
    v_mfma_f32_32x32x16_bf16 v[64:79], a[20:23], v[212:215], v[64:79]
    v_exp_f32 v154, v154
    v_exp_f32 v155, v155
    v_exp_f32_e64 v156, v156
    v_mfma_f32_32x32x16_bf16 v[16:31], a[216:219], v[252:255], v[16:31]
    v_exp_f32 v157, v157
    v_exp_f32 v158, v158
    v_exp_f32_e64 v159, v159
    v_mfma_f32_32x32x16_bf16 v[32:47], a[220:223], v[252:255], v[32:47]
    v_rcp_f32 v128, v128
    v_rcp_f32 v129, v129
    v_rcp_f32_e64 v130, v130
    v_mfma_f32_32x32x16_bf16 v[48:63], a[224:227], v[252:255], v[48:63]
    v_rcp_f32 v131, v131
    v_rcp_f32 v132, v132
    v_rcp_f32_e64 v133, v133
    v_mfma_f32_32x32x16_bf16 v[16:31], a[228:231], v[12:15], v[16:31]
    v_rcp_f32 v134, v134
    v_rcp_f32 v135, v135
    v_rcp_f32_e64 v136, v136
    v_mfma_f32_32x32x16_bf16 v[32:47], a[232:235], v[12:15], v[32:47]
    v_rcp_f32 v137, v137
    v_rcp_f32 v138, v138
    v_rcp_f32_e64 v139, v139
    v_mfma_f32_32x32x16_bf16 v[48:63], a[236:239], v[12:15], v[48:63]
    s_waitcnt lgkmcnt(0)
    v_rcp_f32 v140, v140
    v_rcp_f32 v141, v141
    v_rcp_f32 v142, v142
    v_rcp_f32_e64 v143, v143
    v_pk_add_f32 v[228:229], v[228:229], v[240:241]
    v_pk_add_f32 v[230:231], v[230:231], v[242:243]
L_pad4:
    s_cbranch_execz L_padret4
    s_nop 0
    v_pk_add_f32 v[232:233], v[232:233], v[244:245]
    v_pk_add_f32 v[234:235], v[234:235], v[246:247]
    v_pk_add_f32 v[236:237], v[236:237], v[248:249]
    v_pk_add_f32 v[238:239], v[238:239], v[250:251]
    v_pk_fma_f32 v[144:145], v[144:145], s[54:55], s[54:55]
    v_pk_fma_f32 v[146:147], v[146:147], s[54:55], s[54:55]
    v_pk_fma_f32 v[148:149], v[148:149], s[54:55], s[54:55]
    v_pk_fma_f32 v[150:151], v[150:151], s[54:55], s[54:55]
    v_pk_fma_f32 v[152:153], v[152:153], s[54:55], s[54:55]
    v_pk_fma_f32 v[154:155], v[154:155], s[54:55], s[54:55]
    v_pk_fma_f32 v[156:157], v[156:157], s[54:55], s[54:55]
    v_pk_fma_f32 v[158:159], v[158:159], s[54:55], s[54:55]
    v_pk_mul_f32 v[128:129], v[80:81], v[128:129]
    v_pk_mul_f32 v[130:131], v[82:83], v[130:131]
    v_pk_mul_f32 v[132:133], v[84:85], v[132:133]
    v_pk_mul_f32 v[134:135], v[86:87], v[134:135]
    v_pk_mul_f32 v[136:137], v[88:89], v[136:137]
    v_pk_mul_f32 v[138:139], v[90:91], v[138:139]
    v_pk_mul_f32 v[140:141], v[92:93], v[140:141]
    v_pk_mul_f32 v[142:143], v[94:95], v[142:143]
    v_pk_fma_f32 v[112:113], v[64:65], v[64:65], s[52:53]
    v_pk_fma_f32 v[114:115], v[66:67], v[66:67], s[52:53]
    v_pk_fma_f32 v[116:117], v[68:69], v[68:69], s[52:53]
    v_pk_fma_f32 v[118:119], v[70:71], v[70:71], s[52:53]
    v_pk_fma_f32 v[120:121], v[72:73], v[72:73], s[52:53]
    v_pk_fma_f32 v[122:123], v[74:75], v[74:75], s[52:53]
    v_pk_fma_f32 v[124:125], v[76:77], v[76:77], s[52:53]
    v_pk_fma_f32 v[126:127], v[78:79], v[78:79], s[52:53]
    v_pk_mul_f32 v[112:113], v[64:65], v[112:113] neg_lo:[1,0] neg_hi:[1,0]
    v_pk_mul_f32 v[114:115], v[66:67], v[114:115] neg_lo:[1,0] neg_hi:[1,0]
    v_pk_mul_f32 v[116:117], v[68:69], v[116:117] neg_lo:[1,0] neg_hi:[1,0]
    v_pk_mul_f32 v[118:119], v[70:71], v[118:119] neg_lo:[1,0] neg_hi:[1,0]
    v_pk_mul_f32 v[120:121], v[72:73], v[120:121] neg_lo:[1,0] neg_hi:[1,0]
    v_pk_mul_f32 v[122:123], v[74:75], v[122:123] neg_lo:[1,0] neg_hi:[1,0]
    v_pk_mul_f32 v[124:125], v[76:77], v[124:125] neg_lo:[1,0] neg_hi:[1,0]
    v_pk_mul_f32 v[126:127], v[78:79], v[126:127] neg_lo:[1,0] neg_hi:[1,0]
    v_mfma_f32_32x32x16_bf16 v[80:95], a[24:27], v[192:195], 0
    v_cvt_pk_bf16_f32 v252, v128, v129
    v_cvt_pk_bf16_f32 v253, v130, v131
    v_cvt_pk_bf16_f32 v254, v132, v133
    v_cvt_pk_bf16_f32 v255, v134, v135
    v_cvt_pk_bf16_f32 v12, v136, v137
    v_cvt_pk_bf16_f32 v13, v138, v139
    v_mfma_f32_32x32x16_bf16 v[80:95], a[28:31], v[196:199], v[80:95]
    v_cvt_pk_bf16_f32 v14, v140, v141
    v_cvt_pk_bf16_f32 v15, v142, v143
    v_cvt_pk_bf16_f32 v240, v216, v217
    v_cvt_pk_bf16_f32 v241, v218, v219
    v_cvt_pk_bf16_f32 v242, v220, v221
    v_cvt_pk_bf16_f32 v243, v222, v223
    v_mfma_f32_32x32x16_bf16 v[80:95], a[32:35], v[200:203], v[80:95]
    v_cvt_pk_bf16_f32 v244, v224, v225
    v_cvt_pk_bf16_f32 v245, v226, v227
    v_cvt_pk_bf16_f32 v246, v228, v229
    v_cvt_pk_bf16_f32 v247, v230, v231
    v_cvt_pk_bf16_f32 v248, v232, v233
    v_cvt_pk_bf16_f32 v249, v234, v235
    v_mfma_f32_32x32x16_bf16 v[80:95], a[36:39], v[204:207], v[80:95]
    v_cvt_pk_bf16_f32 v250, v236, v237
    v_cvt_pk_bf16_f32 v251, v238, v239
    v_exp_f32 v112, v112
    v_exp_f32 v113, v113
    v_mfma_f32_32x32x16_bf16 v[80:95], a[40:43], v[208:211], v[80:95]
    buffer_store_dwordx4 v[240:243], v0, s[44:47], 0 offen offset:0 sc0 sc1
    v_exp_f32 v114, v114
    v_exp_f32 v115, v115
    v_mfma_f32_32x32x16_bf16 v[80:95], a[44:47], v[212:215], v[80:95]
    v_exp_f32 v116, v116
    v_exp_f32 v117, v117
    v_exp_f32_e64 v118, v118
    v_mfma_f32_32x32x16_bf16 v[16:31], a[240:243], v[252:255], v[16:31]
    buffer_store_dwordx4 v[244:247], v0, s[44:47], 0 offen offset:64 sc0 sc1
    v_exp_f32 v119, v119
    v_exp_f32 v120, v120
    v_mfma_f32_32x32x16_bf16 v[32:47], a[244:247], v[252:255], v[32:47]
    v_exp_f32 v121, v121
    v_exp_f32 v122, v122
    v_exp_f32_e64 v123, v123
    v_mfma_f32_32x32x16_bf16 v[48:63], a[248:251], v[252:255], v[48:63]
    buffer_store_dwordx4 v[248:251], v0, s[44:47], 0 offen offset:128 sc0 sc1
    v_exp_f32 v124, v124
    v_exp_f32 v125, v125
    v_mfma_f32_32x32x16_bf16 v[16:31], a[252:255], v[12:15], v[16:31]
    v_exp_f32 v126, v126
    v_exp_f32 v127, v127
    v_rcp_f32_e64 v144, v144
    v_mfma_f32_32x32x16_bf16 v[32:47], v[160:163], v[12:15], v[32:47]
    v_rcp_f32 v145, v145
    v_rcp_f32 v146, v146
    v_rcp_f32_e64 v147, v147
    v_mfma_f32_32x32x16_bf16 v[48:63], v[164:167], v[12:15], v[48:63]
    v_rcp_f32 v148, v148
    v_rcp_f32 v149, v149
    v_rcp_f32 v150, v150
    v_rcp_f32 v151, v151
    v_rcp_f32 v152, v152
    v_rcp_f32 v153, v153
    v_rcp_f32 v154, v154
    v_rcp_f32 v155, v155
    v_rcp_f32 v156, v156
    v_rcp_f32 v157, v157
    v_rcp_f32 v158, v158
    v_rcp_f32 v159, v159
    v_pk_fma_f32 v[112:113], v[112:113], s[54:55], s[54:55]
    v_pk_fma_f32 v[114:115], v[114:115], s[54:55], s[54:55]
    v_pk_fma_f32 v[116:117], v[116:117], s[54:55], s[54:55]
    v_pk_fma_f32 v[118:119], v[118:119], s[54:55], s[54:55]
    v_pk_fma_f32 v[120:121], v[120:121], s[54:55], s[54:55]
    v_pk_fma_f32 v[122:123], v[122:123], s[54:55], s[54:55]
    v_pk_fma_f32 v[124:125], v[124:125], s[54:55], s[54:55]
    v_pk_fma_f32 v[126:127], v[126:127], s[54:55], s[54:55]
    v_pk_mul_f32 v[144:145], v[96:97], v[144:145]
    v_pk_mul_f32 v[146:147], v[98:99], v[146:147]
    v_pk_mul_f32 v[148:149], v[100:101], v[148:149]
    v_pk_mul_f32 v[150:151], v[102:103], v[150:151]
    v_pk_mul_f32 v[152:153], v[104:105], v[152:153]
    v_pk_mul_f32 v[154:155], v[106:107], v[154:155]
    v_pk_mul_f32 v[156:157], v[108:109], v[156:157]
    v_pk_mul_f32 v[158:159], v[110:111], v[158:159]
    v_pk_fma_f32 v[128:129], v[80:81], v[80:81], s[52:53]
    v_pk_fma_f32 v[130:131], v[82:83], v[82:83], s[52:53]
    v_pk_fma_f32 v[132:133], v[84:85], v[84:85], s[52:53]
    v_pk_fma_f32 v[134:135], v[86:87], v[86:87], s[52:53]
    v_pk_fma_f32 v[136:137], v[88:89], v[88:89], s[52:53]
    v_pk_fma_f32 v[138:139], v[90:91], v[90:91], s[52:53]
    v_pk_fma_f32 v[140:141], v[92:93], v[92:93], s[52:53]
    v_pk_fma_f32 v[142:143], v[94:95], v[94:95], s[52:53]
    v_pk_mul_f32 v[128:129], v[80:81], v[128:129] neg_lo:[1,0] neg_hi:[1,0]
    v_pk_mul_f32 v[130:131], v[82:83], v[130:131] neg_lo:[1,0] neg_hi:[1,0]
    v_pk_mul_f32 v[132:133], v[84:85], v[132:133] neg_lo:[1,0] neg_hi:[1,0]
    v_pk_mul_f32 v[134:135], v[86:87], v[134:135] neg_lo:[1,0] neg_hi:[1,0]
    v_pk_mul_f32 v[136:137], v[88:89], v[136:137] neg_lo:[1,0] neg_hi:[1,0]
    v_pk_mul_f32 v[138:139], v[90:91], v[138:139] neg_lo:[1,0] neg_hi:[1,0]
    v_pk_mul_f32 v[140:141], v[92:93], v[140:141] neg_lo:[1,0] neg_hi:[1,0]
    v_pk_mul_f32 v[142:143], v[94:95], v[142:143] neg_lo:[1,0] neg_hi:[1,0]
    v_mfma_f32_32x32x16_bf16 v[96:111], a[48:51], v[192:195], 0
    buffer_load_dwordx4 v[240:243], v4, s[24:27], 0 offen offset:0
    v_cvt_pk_bf16_f32 v252, v144, v145
    v_cvt_pk_bf16_f32 v253, v146, v147
    v_cvt_pk_bf16_f32 v254, v148, v149
    v_cvt_pk_bf16_f32 v255, v150, v151
    v_cvt_pk_bf16_f32 v12, v152, v153
    s_nop 0
    v_mfma_f32_32x32x16_bf16 v[16:31], v[168:171], v[252:255], v[16:31]
    v_cvt_pk_bf16_f32 v13, v154, v155
    v_cvt_pk_bf16_f32 v14, v156, v157
    v_cvt_pk_bf16_f32 v15, v158, v159
    v_exp_f32 v128, v128
    v_exp_f32_e64 v129, v129
    v_mfma_f32_32x32x16_bf16 v[96:111], a[52:55], v[196:199], v[96:111]
    buffer_load_dwordx4 v[244:247], v4, s[24:27], 0 offen offset:64
    v_exp_f32 v130, v130
    v_exp_f32 v131, v131
    v_exp_f32_e64 v132, v132
    v_mfma_f32_32x32x16_bf16 v[16:31], v[180:183], v[12:15], v[16:31]
    v_exp_f32 v133, v133
    v_exp_f32 v134, v134
    v_exp_f32_e64 v135, v135
    v_mfma_f32_32x32x16_bf16 v[96:111], a[56:59], v[200:203], v[96:111]
    buffer_load_dwordx4 v[248:251], v4, s[24:27], 0 offen offset:128
    v_exp_f32 v136, v136
    v_exp_f32 v137, v137
    v_exp_f32_e64 v138, v138
    v_mfma_f32_32x32x16_bf16 v[32:47], v[172:175], v[252:255], v[32:47]
    s_nop 2
    ds_write_b128 v2, v[16:19] offset:52224
    v_exp_f32 v139, v139
    v_mfma_f32_32x32x16_bf16 v[96:111], a[60:63], v[204:207], v[96:111]
    v_exp_f32 v140, v140
    v_exp_f32 v141, v141
    v_exp_f32_e64 v142, v142
    v_mfma_f32_32x32x16_bf16 v[32:47], v[184:187], v[12:15], v[32:47]
    ds_write_b128 v2, v[20:23] offset:53312
    v_exp_f32_e64 v143, v143
    v_mfma_f32_32x32x16_bf16 v[96:111], a[64:67], v[208:211], v[96:111]
    v_rcp_f32 v112, v112
    v_rcp_f32 v113, v113
    v_rcp_f32_e64 v114, v114
    v_mfma_f32_32x32x16_bf16 v[48:63], v[176:179], v[252:255], v[48:63]
    ds_write_b128 v2, v[24:27] offset:54400
    v_rcp_f32_e64 v115, v115
    v_mfma_f32_32x32x16_bf16 v[96:111], a[68:71], v[212:215], v[96:111]
    v_rcp_f32 v116, v116
    v_rcp_f32 v117, v117
    v_rcp_f32_e64 v118, v118
    v_mfma_f32_32x32x16_bf16 v[48:63], v[188:191], v[12:15], v[48:63]
    ds_write_b128 v2, v[28:31] offset:55488
    v_rcp_f32 v119, v119
    v_rcp_f32 v120, v120
    v_rcp_f32 v121, v121
    v_rcp_f32 v122, v122
    v_rcp_f32 v123, v123
    v_rcp_f32 v124, v124
    v_rcp_f32 v125, v125
    v_rcp_f32 v126, v126
    v_rcp_f32_e64 v127, v127
    v_pk_fma_f32 v[128:129], v[128:129], s[54:55], s[54:55]
    v_pk_fma_f32 v[130:131], v[130:131], s[54:55], s[54:55]
    v_pk_fma_f32 v[132:133], v[132:133], s[54:55], s[54:55]
    v_pk_fma_f32 v[134:135], v[134:135], s[54:55], s[54:55]
    v_pk_fma_f32 v[136:137], v[136:137], s[54:55], s[54:55]
    v_pk_fma_f32 v[138:139], v[138:139], s[54:55], s[54:55]
    ds_write_b128 v2, v[40:43] offset:58752
    v_pk_fma_f32 v[140:141], v[140:141], s[54:55], s[54:55]
    v_pk_fma_f32 v[142:143], v[142:143], s[54:55], s[54:55]
    v_pk_mul_f32 v[112:113], v[64:65], v[112:113]
    v_pk_mul_f32 v[114:115], v[66:67], v[114:115]
    v_pk_mul_f32 v[116:117], v[68:69], v[116:117]
    v_pk_mul_f32 v[118:119], v[70:71], v[118:119]
    v_pk_mul_f32 v[120:121], v[72:73], v[120:121]
    v_pk_mul_f32 v[122:123], v[74:75], v[122:123]
    v_pk_mul_f32 v[124:125], v[76:77], v[124:125]
    v_pk_mul_f32 v[126:127], v[78:79], v[126:127]
    v_pk_fma_f32 v[144:145], v[96:97], v[96:97], s[52:53]
    v_pk_fma_f32 v[146:147], v[98:99], v[98:99], s[52:53]
    ds_write_b128 v2, v[36:39] offset:57664
    v_pk_fma_f32 v[148:149], v[100:101], v[100:101], s[52:53]
    v_pk_fma_f32 v[150:151], v[102:103], v[102:103], s[52:53]
    v_pk_fma_f32 v[152:153], v[104:105], v[104:105], s[52:53]
    v_pk_fma_f32 v[154:155], v[106:107], v[106:107], s[52:53]
    v_pk_fma_f32 v[156:157], v[108:109], v[108:109], s[52:53]
    v_pk_fma_f32 v[158:159], v[110:111], v[110:111], s[52:53]
    v_pk_mul_f32 v[144:145], v[96:97], v[144:145] neg_lo:[1,0] neg_hi:[1,0]
    v_pk_mul_f32 v[146:147], v[98:99], v[146:147] neg_lo:[1,0] neg_hi:[1,0]
    v_pk_mul_f32 v[148:149], v[100:101], v[148:149] neg_lo:[1,0] neg_hi:[1,0]
    v_pk_mul_f32 v[150:151], v[102:103], v[150:151] neg_lo:[1,0] neg_hi:[1,0]
    v_pk_mul_f32 v[152:153], v[104:105], v[152:153] neg_lo:[1,0] neg_hi:[1,0]
    v_pk_mul_f32 v[154:155], v[106:107], v[154:155] neg_lo:[1,0] neg_hi:[1,0]
    ds_write_b128 v2, v[32:35] offset:56576
    v_pk_mul_f32 v[156:157], v[108:109], v[156:157] neg_lo:[1,0] neg_hi:[1,0]
    v_pk_mul_f32 v[158:159], v[110:111], v[158:159] neg_lo:[1,0] neg_hi:[1,0]
    v_mfma_f32_32x32x16_bf16 v[64:79], a[72:75], v[192:195], 0
    v_cvt_pk_bf16_f32 v252, v112, v113
    v_cvt_pk_bf16_f32 v253, v114, v115
    v_cvt_pk_bf16_f32 v254, v116, v117
    v_cvt_pk_bf16_f32 v255, v118, v119
    v_cvt_pk_bf16_f32 v12, v120, v121
    v_cvt_pk_bf16_f32 v13, v122, v123
    v_mfma_f32_32x32x16_bf16 v[64:79], a[76:79], v[196:199], v[64:79]
    ds_write_b128 v2, v[44:47] offset:59840
    v_cvt_pk_bf16_f32 v14, v124, v125
    v_mfma_f32_32x32x16_bf16 v[64:79], a[80:83], v[200:203], v[64:79]
    v_cvt_pk_bf16_f32 v15, v126, v127
    v_exp_f32 v144, v144
    v_exp_f32 v145, v145
    v_exp_f32_e64 v146, v146
    v_mfma_f32_32x32x16_bf16 v[64:79], a[84:87], v[204:207], v[64:79]
    ds_write_b128 v2, v[48:51] offset:60928
    v_exp_f32_e64 v147, v147
    v_mfma_f32_32x32x16_bf16 v[64:79], a[88:91], v[208:211], v[64:79]
    v_exp_f32 v148, v148
    v_exp_f32 v149, v149
    v_exp_f32_e64 v150, v150
    v_mfma_f32_32x32x16_bf16 v[64:79], a[92:95], v[212:215], v[64:79]
    ds_write_b128 v2, v[52:55] offset:62016
    v_exp_f32_e64 v151, v151
    v_mfma_f32_32x32x16_bf16 v[16:31], a[192:195], v[252:255], 0
    v_exp_f32 v152, v152
    v_exp_f32 v153, v153
    v_exp_f32_e64 v154, v154
    v_mfma_f32_32x32x16_bf16 v[16:31], a[204:207], v[12:15], v[16:31]
    ds_write_b128 v2, v[56:59] offset:63104
    v_exp_f32_e64 v155, v155
    v_mfma_f32_32x32x16_bf16 v[32:47], a[196:199], v[252:255], 0
    v_exp_f32 v156, v156
    v_exp_f32 v157, v157
    v_exp_f32_e64 v158, v158
    v_mfma_f32_32x32x16_bf16 v[32:47], a[208:211], v[12:15], v[32:47]
    ds_write_b128 v2, v[60:63] offset:64192
    v_exp_f32_e64 v159, v159
    v_mfma_f32_32x32x16_bf16 v[48:63], a[200:203], v[252:255], 0
    v_rcp_f32 v128, v128
    v_rcp_f32 v129, v129
    v_rcp_f32_e64 v130, v130
    v_mfma_f32_32x32x16_bf16 v[48:63], a[212:215], v[12:15], v[48:63]
    v_rcp_f32 v131, v131
    v_rcp_f32 v132, v132
    v_rcp_f32 v133, v133
    v_rcp_f32 v134, v134
    v_rcp_f32 v135, v135
    v_rcp_f32 v136, v136
    v_rcp_f32 v137, v137
    v_rcp_f32 v138, v138
    v_rcp_f32 v139, v139
    v_rcp_f32 v140, v140
    v_rcp_f32 v141, v141
    v_rcp_f32 v142, v142
    v_rcp_f32_e64 v143, v143
    v_pk_fma_f32 v[144:145], v[144:145], s[54:55], s[54:55]
    v_pk_fma_f32 v[146:147], v[146:147], s[54:55], s[54:55]
    v_pk_fma_f32 v[148:149], v[148:149], s[54:55], s[54:55]
    v_pk_fma_f32 v[150:151], v[150:151], s[54:55], s[54:55]
    v_pk_fma_f32 v[152:153], v[152:153], s[54:55], s[54:55]
    v_pk_fma_f32 v[154:155], v[154:155], s[54:55], s[54:55]
    v_pk_fma_f32 v[156:157], v[156:157], s[54:55], s[54:55]
    v_pk_fma_f32 v[158:159], v[158:159], s[54:55], s[54:55]
    v_pk_mul_f32 v[128:129], v[80:81], v[128:129]
    v_pk_mul_f32 v[130:131], v[82:83], v[130:131]
    v_pk_mul_f32 v[132:133], v[84:85], v[132:133]
    v_pk_mul_f32 v[134:135], v[86:87], v[134:135]
    v_pk_mul_f32 v[136:137], v[88:89], v[136:137]
    v_pk_mul_f32 v[138:139], v[90:91], v[138:139]
    v_pk_mul_f32 v[140:141], v[92:93], v[140:141]
    v_pk_mul_f32 v[142:143], v[94:95], v[142:143]
    v_pk_fma_f32 v[112:113], v[64:65], v[64:65], s[52:53]
    v_pk_fma_f32 v[114:115], v[66:67], v[66:67], s[52:53]
    v_pk_fma_f32 v[116:117], v[68:69], v[68:69], s[52:53]
    v_pk_fma_f32 v[118:119], v[70:71], v[70:71], s[52:53]
    v_pk_fma_f32 v[120:121], v[72:73], v[72:73], s[52:53]
    v_pk_fma_f32 v[122:123], v[74:75], v[74:75], s[52:53]
    v_pk_fma_f32 v[124:125], v[76:77], v[76:77], s[52:53]
    v_pk_fma_f32 v[126:127], v[78:79], v[78:79], s[52:53]
    v_pk_mul_f32 v[112:113], v[64:65], v[112:113] neg_lo:[1,0] neg_hi:[1,0]
    v_pk_mul_f32 v[114:115], v[66:67], v[114:115] neg_lo:[1,0] neg_hi:[1,0]
    v_pk_mul_f32 v[116:117], v[68:69], v[116:117] neg_lo:[1,0] neg_hi:[1,0]
    v_pk_mul_f32 v[118:119], v[70:71], v[118:119] neg_lo:[1,0] neg_hi:[1,0]
    v_pk_mul_f32 v[120:121], v[72:73], v[120:121] neg_lo:[1,0] neg_hi:[1,0]
    v_pk_mul_f32 v[122:123], v[74:75], v[122:123] neg_lo:[1,0] neg_hi:[1,0]
    v_pk_mul_f32 v[124:125], v[76:77], v[124:125] neg_lo:[1,0] neg_hi:[1,0]
    v_pk_mul_f32 v[126:127], v[78:79], v[126:127] neg_lo:[1,0] neg_hi:[1,0]
    v_mfma_f32_32x32x16_bf16 v[80:95], a[96:99], v[192:195], 0
    s_waitcnt lgkmcnt(0)
    s_barrier
    v_cvt_pk_bf16_f32 v252, v128, v129
    v_mfma_f32_32x32x16_bf16 v[80:95], a[100:103], v[196:199], v[80:95]
    ds_read_b128 v[216:219], v5 offset:0
    v_cvt_pk_bf16_f32 v253, v130, v131
    v_cvt_pk_bf16_f32 v254, v132, v133
    v_cvt_pk_bf16_f32 v255, v134, v135
    v_cvt_pk_bf16_f32 v12, v136, v137
    v_cvt_pk_bf16_f32 v13, v138, v139
    v_mfma_f32_32x32x16_bf16 v[80:95], a[104:107], v[200:203], v[80:95]
    ds_read_b128 v[220:223], v5 offset:512
    v_cvt_pk_bf16_f32 v14, v140, v141
    v_cvt_pk_bf16_f32 v15, v142, v143
    v_exp_f32 v112, v112
    v_exp_f32 v113, v113
    v_mfma_f32_32x32x16_bf16 v[80:95], a[108:111], v[204:207], v[80:95]
    ds_read_b128 v[224:227], v5 offset:4352
    v_exp_f32 v114, v114
    v_exp_f32 v115, v115
    v_exp_f32_e64 v116, v116
    v_mfma_f32_32x32x16_bf16 v[80:95], a[112:115], v[208:211], v[80:95]
    ds_read_b128 v[228:231], v5 offset:4864
    v_exp_f32 v117, v117
    v_exp_f32 v118, v118
    v_exp_f32_e64 v119, v119
    v_mfma_f32_32x32x16_bf16 v[80:95], a[116:119], v[212:215], v[80:95]
    ds_read_b128 v[232:235], v5 offset:8704
    v_exp_f32 v120, v120
    v_exp_f32 v121, v121
    v_exp_f32_e64 v122, v122
    v_mfma_f32_32x32x16_bf16 v[16:31], a[144:147], v[252:255], v[16:31]
    ds_read_b128 v[236:239], v5 offset:9216
    v_exp_f32 v123, v123
    v_exp_f32 v124, v124
    v_exp_f32_e64 v125, v125
    v_mfma_f32_32x32x16_bf16 v[32:47], a[148:151], v[252:255], v[32:47]
    v_exp_f32 v126, v126
    v_exp_f32 v127, v127
    v_rcp_f32_e64 v144, v144
    v_mfma_f32_32x32x16_bf16 v[48:63], a[152:155], v[252:255], v[48:63]
    v_rcp_f32 v145, v145
    v_rcp_f32 v146, v146
    v_rcp_f32_e64 v147, v147
    v_mfma_f32_32x32x16_bf16 v[16:31], a[156:159], v[12:15], v[16:31]
    v_rcp_f32 v148, v148
    v_rcp_f32 v149, v149
    v_rcp_f32_e64 v150, v150
    v_mfma_f32_32x32x16_bf16 v[32:47], a[160:163], v[12:15], v[32:47]
    v_rcp_f32 v151, v151
    v_rcp_f32 v152, v152
    v_rcp_f32_e64 v153, v153
    v_mfma_f32_32x32x16_bf16 v[48:63], a[164:167], v[12:15], v[48:63]
    s_waitcnt vmcnt(0) lgkmcnt(0)
    v_rcp_f32 v154, v154
    v_rcp_f32 v155, v155
    v_rcp_f32 v156, v156
    v_rcp_f32 v157, v157
    v_rcp_f32 v158, v158
    v_rcp_f32_e64 v159, v159
    v_dot2_f32_bf16 v216, v240, s68, v216
    v_dot2_f32_bf16 v217, v240, s69, v217
    v_dot2_f32_bf16 v218, v241, s68, v218
    v_dot2_f32_bf16 v219, v241, s69, v219
    v_dot2_f32_bf16 v220, v242, s68, v220
    v_dot2_f32_bf16 v221, v242, s69, v221
    v_dot2_f32_bf16 v222, v243, s68, v222
    v_dot2_f32_bf16 v223, v243, s69, v223
    v_dot2_f32_bf16 v224, v244, s68, v224
    v_dot2_f32_bf16 v225, v244, s69, v225
    v_dot2_f32_bf16 v226, v245, s68, v226
    v_dot2_f32_bf16 v227, v245, s69, v227
    v_dot2_f32_bf16 v228, v246, s68, v228
    v_dot2_f32_bf16 v229, v246, s69, v229
    v_dot2_f32_bf16 v230, v247, s68, v230
    v_dot2_f32_bf16 v231, v247, s69, v231
    v_dot2_f32_bf16 v232, v248, s68, v232
    v_dot2_f32_bf16 v233, v248, s69, v233
    v_dot2_f32_bf16 v234, v249, s68, v234
    v_dot2_f32_bf16 v235, v249, s69, v235
    v_dot2_f32_bf16 v236, v250, s68, v236
    v_dot2_f32_bf16 v237, v250, s69, v237
    v_dot2_f32_bf16 v238, v251, s68, v238
    v_dot2_f32_bf16 v239, v251, s69, v239
    v_pk_fma_f32 v[112:113], v[112:113], s[54:55], s[54:55]
    v_pk_fma_f32 v[114:115], v[114:115], s[54:55], s[54:55]
    v_pk_fma_f32 v[116:117], v[116:117], s[54:55], s[54:55]
    v_pk_fma_f32 v[118:119], v[118:119], s[54:55], s[54:55]
    v_pk_fma_f32 v[120:121], v[120:121], s[54:55], s[54:55]
    v_pk_fma_f32 v[122:123], v[122:123], s[54:55], s[54:55]
    v_pk_fma_f32 v[124:125], v[124:125], s[54:55], s[54:55]
    v_pk_fma_f32 v[126:127], v[126:127], s[54:55], s[54:55]
    v_pk_mul_f32 v[144:145], v[96:97], v[144:145]
    v_pk_mul_f32 v[146:147], v[98:99], v[146:147]
    v_pk_mul_f32 v[148:149], v[100:101], v[148:149]
    v_pk_mul_f32 v[150:151], v[102:103], v[150:151]
    v_pk_mul_f32 v[152:153], v[104:105], v[152:153]
    v_pk_mul_f32 v[154:155], v[106:107], v[154:155]
    v_pk_mul_f32 v[156:157], v[108:109], v[156:157]
    v_pk_mul_f32 v[158:159], v[110:111], v[158:159]
    v_pk_fma_f32 v[128:129], v[80:81], v[80:81], s[52:53]
    v_pk_fma_f32 v[130:131], v[82:83], v[82:83], s[52:53]
    v_pk_fma_f32 v[132:133], v[84:85], v[84:85], s[52:53]
    v_pk_fma_f32 v[134:135], v[86:87], v[86:87], s[52:53]
    v_pk_fma_f32 v[136:137], v[88:89], v[88:89], s[52:53]
    v_pk_fma_f32 v[138:139], v[90:91], v[90:91], s[52:53]
    v_pk_fma_f32 v[140:141], v[92:93], v[92:93], s[52:53]
    v_pk_fma_f32 v[142:143], v[94:95], v[94:95], s[52:53]
    v_pk_mul_f32 v[128:129], v[80:81], v[128:129] neg_lo:[1,0] neg_hi:[1,0]
    v_pk_mul_f32 v[130:131], v[82:83], v[130:131] neg_lo:[1,0] neg_hi:[1,0]
    v_pk_mul_f32 v[132:133], v[84:85], v[132:133] neg_lo:[1,0] neg_hi:[1,0]
    v_pk_mul_f32 v[134:135], v[86:87], v[134:135] neg_lo:[1,0] neg_hi:[1,0]
    v_pk_mul_f32 v[136:137], v[88:89], v[136:137] neg_lo:[1,0] neg_hi:[1,0]
    v_pk_mul_f32 v[138:139], v[90:91], v[138:139] neg_lo:[1,0] neg_hi:[1,0]
    v_pk_mul_f32 v[140:141], v[92:93], v[140:141] neg_lo:[1,0] neg_hi:[1,0]
    v_pk_mul_f32 v[142:143], v[94:95], v[142:143] neg_lo:[1,0] neg_hi:[1,0]
    v_mfma_f32_32x32x16_bf16 v[96:111], a[120:123], v[192:195], 0
    ds_read_b128 v[240:243], v5 offset:13056
    v_cvt_pk_bf16_f32 v252, v144, v145
    v_cvt_pk_bf16_f32 v253, v146, v147
    v_cvt_pk_bf16_f32 v254, v148, v149
    v_cvt_pk_bf16_f32 v255, v150, v151
    v_cvt_pk_bf16_f32 v12, v152, v153
    v_mfma_f32_32x32x16_bf16 v[96:111], a[124:127], v[196:199], v[96:111]
    ds_read_b128 v[244:247], v5 offset:13568
    v_cvt_pk_bf16_f32 v13, v154, v155
    v_cvt_pk_bf16_f32 v14, v156, v157
    v_cvt_pk_bf16_f32 v15, v158, v159
    v_exp_f32_e64 v128, v128
    v_mfma_f32_32x32x16_bf16 v[96:111], a[128:131], v[200:203], v[96:111]
    ds_read_b128 v[248:251], v5 offset:17408
    v_exp_f32 v129, v129
    v_exp_f32 v130, v130
    v_exp_f32_e64 v131, v131
    v_mfma_f32_32x32x16_bf16 v[96:111], a[132:135], v[204:207], v[96:111]
    ds_read_b128 a[72:75], v6 offset:0
    ds_read_b128 a[76:79], v6 offset:6304
    v_exp_f32 v132, v132
    v_exp_f32 v133, v133
    v_mfma_f32_32x32x16_bf16 v[96:111], a[136:139], v[208:211], v[96:111]
    ds_read_b128 a[80:83], v6 offset:12608
    ds_read_b128 a[84:87], v6 offset:18912
    v_exp_f32 v134, v134
    v_exp_f32 v135, v135
    v_mfma_f32_32x32x16_bf16 v[96:111], a[140:143], v[212:215], v[96:111]
    ds_read_b128 a[88:91], v6 offset:25216
    ds_read_b128 a[92:95], v6 offset:31520
    v_exp_f32 v136, v136
    v_exp_f32 v137, v137
    v_mfma_f32_32x32x16_bf16 v[16:31], a[168:171], v[252:255], v[16:31]
    ds_read_b128 v[204:207], v5 offset:17920
    v_exp_f32 v138, v138
    v_exp_f32 v139, v139
    v_exp_f32_e64 v140, v140
    v_mfma_f32_32x32x16_bf16 v[32:47], a[172:175], v[252:255], v[32:47]
    ds_read_b128 v[208:211], v5 offset:21760
    buffer_load_dwordx4 v[192:195], v11, s[24:27], 0 offen offset:0
    v_exp_f32 v141, v141
    v_exp_f32 v142, v142
    v_mfma_f32_32x32x16_bf16 v[48:63], a[176:179], v[252:255], v[48:63]
    ds_read_b128 v[212:215], v5 offset:22272
    v_exp_f32 v143, v143
    v_rcp_f32 v112, v112
    v_rcp_f32_e64 v113, v113
    v_mfma_f32_32x32x16_bf16 v[16:31], a[180:183], v[12:15], v[16:31]
    buffer_load_dwordx4 v[196:199], v11, s[24:27], 0 offen offset:64
    v_rcp_f32 v114, v114
    v_rcp_f32 v115, v115
    v_rcp_f32_e64 v116, v116
    v_mfma_f32_32x32x16_bf16 v[32:47], a[184:187], v[12:15], v[32:47]
    buffer_load_dwordx4 v[200:203], v11, s[24:27], 0 offen offset:128
    v_rcp_f32 v117, v117
    v_rcp_f32 v118, v118
    v_rcp_f32_e64 v119, v119
    v_mfma_f32_32x32x16_bf16 v[48:63], a[188:191], v[12:15], v[48:63]
    s_waitcnt lgkmcnt(0)
    v_rcp_f32 v120, v120
    v_rcp_f32 v121, v121
    v_rcp_f32 v122, v122
    v_rcp_f32 v123, v123
    v_rcp_f32 v124, v124
    v_rcp_f32 v125, v125
    v_rcp_f32 v126, v126
    v_rcp_f32_e64 v127, v127
    v_pk_fma_f32 v[128:129], v[128:129], s[54:55], s[54:55]
    v_pk_fma_f32 v[130:131], v[130:131], s[54:55], s[54:55]
    v_pk_fma_f32 v[132:133], v[132:133], s[54:55], s[54:55]
    v_pk_fma_f32 v[134:135], v[134:135], s[54:55], s[54:55]
    v_pk_fma_f32 v[136:137], v[136:137], s[54:55], s[54:55]
    v_pk_fma_f32 v[138:139], v[138:139], s[54:55], s[54:55]
    v_pk_fma_f32 v[140:141], v[140:141], s[54:55], s[54:55]
    v_pk_fma_f32 v[142:143], v[142:143], s[54:55], s[54:55]
    v_pk_mul_f32 v[112:113], v[64:65], v[112:113]
    v_pk_mul_f32 v[114:115], v[66:67], v[114:115]
    v_pk_mul_f32 v[116:117], v[68:69], v[116:117]
    v_pk_mul_f32 v[118:119], v[70:71], v[118:119]
    v_pk_mul_f32 v[120:121], v[72:73], v[120:121]
    v_pk_mul_f32 v[122:123], v[74:75], v[122:123]
    v_pk_mul_f32 v[124:125], v[76:77], v[124:125]
    v_pk_mul_f32 v[126:127], v[78:79], v[126:127]
    v_pk_fma_f32 v[144:145], v[96:97], v[96:97], s[52:53]
    v_pk_fma_f32 v[146:147], v[98:99], v[98:99], s[52:53]
    v_pk_fma_f32 v[148:149], v[100:101], v[100:101], s[52:53]
    v_pk_fma_f32 v[150:151], v[102:103], v[102:103], s[52:53]
    v_pk_fma_f32 v[152:153], v[104:105], v[104:105], s[52:53]
    v_pk_fma_f32 v[154:155], v[106:107], v[106:107], s[52:53]
    v_pk_fma_f32 v[156:157], v[108:109], v[108:109], s[52:53]
    v_pk_fma_f32 v[158:159], v[110:111], v[110:111], s[52:53]
    v_pk_mul_f32 v[144:145], v[96:97], v[144:145] neg_lo:[1,0] neg_hi:[1,0]
    v_pk_mul_f32 v[146:147], v[98:99], v[146:147] neg_lo:[1,0] neg_hi:[1,0]
    v_pk_mul_f32 v[148:149], v[100:101], v[148:149] neg_lo:[1,0] neg_hi:[1,0]
    v_pk_mul_f32 v[150:151], v[102:103], v[150:151] neg_lo:[1,0] neg_hi:[1,0]
    v_pk_mul_f32 v[152:153], v[104:105], v[152:153] neg_lo:[1,0] neg_hi:[1,0]
    v_pk_mul_f32 v[154:155], v[106:107], v[154:155] neg_lo:[1,0] neg_hi:[1,0]
    v_pk_mul_f32 v[156:157], v[108:109], v[156:157] neg_lo:[1,0] neg_hi:[1,0]
    v_pk_mul_f32 v[158:159], v[110:111], v[158:159] neg_lo:[1,0] neg_hi:[1,0]
    v_mfma_f32_16x16x32_bf16 v[64:67], a[0:3], a[72:75], 0
    v_cvt_pk_bf16_f32 v252, v112, v113
    v_cvt_pk_bf16_f32 v253, v114, v115
    v_mfma_f32_16x16x32_bf16 v[64:67], a[4:7], a[76:79], v[64:67]
    v_cvt_pk_bf16_f32 v254, v116, v117
    v_cvt_pk_bf16_f32 v255, v118, v119
    v_mfma_f32_16x16x32_bf16 v[64:67], a[8:11], a[80:83], v[64:67]
    v_cvt_pk_bf16_f32 v12, v120, v121
    v_cvt_pk_bf16_f32 v13, v122, v123
    v_mfma_f32_16x16x32_bf16 v[64:67], a[12:15], a[84:87], v[64:67]
    v_cvt_pk_bf16_f32 v14, v124, v125
    v_cvt_pk_bf16_f32 v15, v126, v127
    v_mfma_f32_16x16x32_bf16 v[64:67], a[16:19], a[88:91], v[64:67]
    v_exp_f32_e64 v144, v144
    v_mfma_f32_16x16x32_bf16 v[64:67], a[20:23], a[92:95], v[64:67]
    v_exp_f32_e64 v145, v145
    v_mfma_f32_16x16x32_bf16 v[68:71], a[24:27], a[72:75], 0
    v_exp_f32_e64 v146, v146
    v_mfma_f32_16x16x32_bf16 v[68:71], a[28:31], a[76:79], v[68:71]
    v_exp_f32_e64 v147, v147
    v_mfma_f32_16x16x32_bf16 v[68:71], a[32:35], a[80:83], v[68:71]
    v_exp_f32_e64 v148, v148
    v_mfma_f32_16x16x32_bf16 v[68:71], a[36:39], a[84:87], v[68:71]
    v_exp_f32_e64 v149, v149
    v_mfma_f32_16x16x32_bf16 v[68:71], a[40:43], a[88:91], v[68:71]
    v_exp_f32_e64 v150, v150
    v_mfma_f32_16x16x32_bf16 v[68:71], a[44:47], a[92:95], v[68:71]
    v_exp_f32_e64 v151, v151
    v_mfma_f32_16x16x32_bf16 v[72:75], a[48:51], a[72:75], 0
    v_exp_f32_e64 v152, v152
    v_mfma_f32_16x16x32_bf16 v[72:75], a[52:55], a[76:79], v[72:75]
    v_exp_f32_e64 v153, v153
    v_mfma_f32_16x16x32_bf16 v[72:75], a[56:59], a[80:83], v[72:75]
L_pad5:
    s_cbranch_execz L_padret5
    v_exp_f32 v154, v154
    v_mfma_f32_16x16x32_bf16 v[72:75], a[60:63], a[84:87], v[72:75]
    v_exp_f32_e64 v155, v155
    v_mfma_f32_16x16x32_bf16 v[72:75], a[64:67], a[88:91], v[72:75]
    v_exp_f32_e64 v156, v156
    v_mfma_f32_16x16x32_bf16 v[72:75], a[68:71], a[92:95], v[72:75]
    v_exp_f32_e64 v157, v157
    v_mfma_f32_32x32x16_bf16 v[16:31], a[216:219], v[252:255], v[16:31]
    v_exp_f32 v158, v158
    v_exp_f32 v159, v159
    v_rcp_f32_e64 v128, v128
    v_mfma_f32_32x32x16_bf16 v[32:47], a[220:223], v[252:255], v[32:47]
    v_rcp_f32 v129, v129
    v_rcp_f32 v130, v130
    v_rcp_f32_e64 v131, v131
    v_mfma_f32_32x32x16_bf16 v[48:63], a[224:227], v[252:255], v[48:63]
    v_rcp_f32 v132, v132
    v_rcp_f32 v133, v133
    v_rcp_f32_e64 v134, v134
    v_mfma_f32_32x32x16_bf16 v[16:31], a[228:231], v[12:15], v[16:31]
    v_rcp_f32 v135, v135
    v_rcp_f32 v136, v136
    v_rcp_f32_e64 v137, v137
    v_mfma_f32_32x32x16_bf16 v[32:47], a[232:235], v[12:15], v[32:47]
    v_rcp_f32 v138, v138
    v_rcp_f32 v139, v139
    v_rcp_f32_e64 v140, v140
    v_mfma_f32_32x32x16_bf16 v[48:63], a[236:239], v[12:15], v[48:63]
    v_rcp_f32 v141, v141
    v_rcp_f32 v142, v142
    v_rcp_f32_e64 v143, v143
    v_fma_f32 v112, v64, v64, s52
    v_fma_f32 v113, v65, v65, s52
    v_fma_f32 v114, v66, v66, s52
    v_fma_f32 v115, v67, v67, s52
    v_fma_f32 v116, v68, v68, s52
    v_fma_f32 v117, v69, v69, s52
    v_fma_f32 v118, v70, v70, s52
    v_fma_f32 v119, v71, v71, s52
    v_fma_f32 v120, v72, v72, s52
    v_fma_f32 v121, v73, v73, s52
    v_fma_f32 v122, v74, v74, s52
    v_fma_f32 v123, v75, v75, s52
    v_mul_f32 v112, -v64, v112
    v_mul_f32 v113, -v65, v113
    v_mul_f32 v114, -v66, v114
    v_mul_f32 v115, -v67, v115
    v_mul_f32 v116, -v68, v116
    v_mul_f32 v117, -v69, v117
    v_mul_f32 v118, -v70, v118
    v_mul_f32 v119, -v71, v119
    v_mul_f32 v120, -v72, v120
    v_mul_f32 v121, -v73, v121
    v_mul_f32 v122, -v74, v122
    v_mul_f32 v123, -v75, v123
    v_exp_f32 v112, v112
    v_exp_f32 v113, v113
    v_exp_f32 v114, v114
    v_exp_f32 v115, v115
    v_exp_f32 v116, v116
    v_exp_f32 v117, v117
    v_exp_f32 v118, v118
    v_exp_f32 v119, v119
    v_exp_f32 v120, v120
    v_exp_f32 v121, v121
    v_exp_f32 v122, v122
    v_exp_f32 v123, v123
    v_pk_fma_f32 v[144:145], v[144:145], s[54:55], s[54:55]
    v_pk_fma_f32 v[146:147], v[146:147], s[54:55], s[54:55]
    v_pk_fma_f32 v[148:149], v[148:149], s[54:55], s[54:55]
    v_pk_fma_f32 v[150:151], v[150:151], s[54:55], s[54:55]
    v_pk_fma_f32 v[152:153], v[152:153], s[54:55], s[54:55]
    v_pk_fma_f32 v[154:155], v[154:155], s[54:55], s[54:55]
    v_pk_fma_f32 v[156:157], v[156:157], s[54:55], s[54:55]
    v_pk_fma_f32 v[158:159], v[158:159], s[54:55], s[54:55]
    v_pk_fma_f32 v[112:113], v[112:113], s[54:55], s[54:55]
    v_pk_fma_f32 v[114:115], v[114:115], s[54:55], s[54:55]
    v_pk_fma_f32 v[116:117], v[116:117], s[54:55], s[54:55]
    v_pk_fma_f32 v[118:119], v[118:119], s[54:55], s[54:55]
    v_pk_fma_f32 v[120:121], v[120:121], s[54:55], s[54:55]
    v_pk_fma_f32 v[122:123], v[122:123], s[54:55], s[54:55]
    v_pk_mul_f32 v[128:129], v[80:81], v[128:129]
    v_pk_mul_f32 v[130:131], v[82:83], v[130:131]
    v_pk_mul_f32 v[132:133], v[84:85], v[132:133]
    v_pk_mul_f32 v[134:135], v[86:87], v[134:135]
    v_pk_mul_f32 v[136:137], v[88:89], v[136:137]
    v_pk_mul_f32 v[138:139], v[90:91], v[138:139]
    v_pk_mul_f32 v[140:141], v[92:93], v[140:141]
    v_pk_mul_f32 v[142:143], v[94:95], v[142:143]
    v_cvt_pk_bf16_f32 v252, v128, v129
    v_cvt_pk_bf16_f32 v253, v130, v131
    v_cvt_pk_bf16_f32 v254, v132, v133
    v_cvt_pk_bf16_f32 v255, v134, v135
    s_nop 1
    s_nop 0
    v_mfma_f32_32x32x16_bf16 v[16:31], a[240:243], v[252:255], v[16:31]
    v_cvt_pk_bf16_f32 v12, v136, v137
    v_cvt_pk_bf16_f32 v13, v138, v139
    v_cvt_pk_bf16_f32 v14, v140, v141
    v_cvt_pk_bf16_f32 v15, v142, v143
    v_rcp_f32_e64 v144, v144
    v_mfma_f32_32x32x16_bf16 v[32:47], a[244:247], v[252:255], v[32:47]
    buffer_load_dwordx2 v[76:77], v10, s[24:27], 0 offen
    v_rcp_f32 v145, v145
    v_rcp_f32 v146, v146
    v_rcp_f32_e64 v147, v147
    v_mfma_f32_32x32x16_bf16 v[48:63], a[248:251], v[252:255], v[48:63]
    v_rcp_f32 v148, v148
    v_rcp_f32 v149, v149
    v_rcp_f32_e64 v150, v150
    v_mfma_f32_32x32x16_bf16 v[16:31], a[252:255], v[12:15], v[16:31]
    v_rcp_f32 v151, v151
    v_rcp_f32 v152, v152
    v_rcp_f32_e64 v153, v153
    v_mfma_f32_32x32x16_bf16 v[32:47], v[160:163], v[12:15], v[32:47]
    v_rcp_f32 v154, v154
    v_rcp_f32 v155, v155
    v_rcp_f32_e64 v156, v156
    v_mfma_f32_32x32x16_bf16 v[48:63], v[164:167], v[12:15], v[48:63]
    v_rcp_f32 v157, v157
    v_rcp_f32 v158, v158
    v_rcp_f32 v159, v159
    v_rcp_f32 v112, v112
    v_rcp_f32 v113, v113
    v_rcp_f32 v114, v114
    v_rcp_f32 v115, v115
    v_rcp_f32 v116, v116
    v_rcp_f32 v117, v117
    v_rcp_f32 v118, v118
    v_rcp_f32 v119, v119
    v_rcp_f32 v120, v120
    v_rcp_f32 v121, v121
    v_rcp_f32 v122, v122
    v_rcp_f32 v123, v123
    v_add_u32 v6, s3, v6
    v_pk_mul_f32 v[144:145], v[96:97], v[144:145]
    v_pk_mul_f32 v[146:147], v[98:99], v[146:147]
    v_pk_mul_f32 v[148:149], v[100:101], v[148:149]
    v_pk_mul_f32 v[150:151], v[102:103], v[150:151]
    v_pk_mul_f32 v[152:153], v[104:105], v[152:153]
    v_pk_mul_f32 v[154:155], v[106:107], v[154:155]
    v_pk_mul_f32 v[156:157], v[108:109], v[156:157]
    v_pk_mul_f32 v[158:159], v[110:111], v[158:159]
    v_pk_mul_f32 v[112:113], v[64:65], v[112:113]
    v_pk_mul_f32 v[114:115], v[66:67], v[114:115]
    v_pk_mul_f32 v[116:117], v[68:69], v[116:117]
    v_pk_mul_f32 v[118:119], v[70:71], v[118:119]
    v_pk_mul_f32 v[120:121], v[72:73], v[120:121]
    v_pk_mul_f32 v[122:123], v[74:75], v[122:123]
    v_cvt_pk_bf16_f32 v252, v144, v145
    v_cvt_pk_bf16_f32 v253, v146, v147
    v_cvt_pk_bf16_f32 v254, v148, v149
    v_cvt_pk_bf16_f32 v255, v150, v151
    s_nop 1
    s_nop 0
    v_mfma_f32_32x32x16_bf16 v[16:31], v[168:171], v[252:255], v[16:31]
    v_cvt_pk_bf16_f32 v12, v152, v153
    v_cvt_pk_bf16_f32 v13, v154, v155
    v_cvt_pk_bf16_f32 v14, v156, v157
    v_cvt_pk_bf16_f32 v15, v158, v159
    v_cvt_pk_bf16_f32 v64, v112, v113
    v_cvt_pk_bf16_f32 v65, v114, v115
    v_mfma_f32_32x32x16_bf16 v[16:31], v[180:183], v[12:15], v[16:31]
    v_cvt_pk_bf16_f32 v66, v116, v117
    v_cvt_pk_bf16_f32 v67, v118, v119
    v_cvt_pk_bf16_f32 v68, v120, v121
    v_cvt_pk_bf16_f32 v69, v122, v123
    v_mfma_f32_32x32x16_bf16 v[32:47], v[172:175], v[252:255], v[32:47]
    ds_write_b64 v9, v[64:65] offset:0
    ds_write_b64 v9, v[66:67] offset:12608
    ds_write_b64 v9, v[68:69] offset:25216
    v_mfma_f32_32x32x16_bf16 v[32:47], v[184:187], v[12:15], v[32:47]
    ds_read_b128 a[96:99], v6 offset:0
    ds_read_b128 a[100:103], v6 offset:6304
    ds_read_b128 a[104:107], v6 offset:12608
    ds_read_b128 a[108:111], v6 offset:18912
    ds_read_b128 a[112:115], v6 offset:25216
    ds_read_b128 a[116:119], v6 offset:31520
    v_mfma_f32_32x32x16_bf16 v[48:63], v[176:179], v[252:255], v[48:63]
    ds_write_b128 v2, v[16:19] offset:0
    v_mfma_f32_32x32x16_bf16 v[48:63], v[188:191], v[12:15], v[48:63]
    ds_write_b128 v2, v[20:23] offset:1088
    ds_write_b128 v2, v[24:27] offset:2176
    v_pk_add_f32 v[216:217], v[216:217], v[240:241]
    v_pk_add_f32 v[218:219], v[218:219], v[242:243]
    v_pk_add_f32 v[220:221], v[220:221], v[244:245]
    v_pk_add_f32 v[222:223], v[222:223], v[246:247]
    v_pk_add_f32 v[224:225], v[224:225], v[248:249]
    v_pk_add_f32 v[226:227], v[226:227], v[250:251]
    ds_write_b128 v2, v[28:31] offset:3264
    v_pk_add_f32 v[228:229], v[228:229], v[204:205]
    v_pk_add_f32 v[230:231], v[230:231], v[206:207]
    v_pk_add_f32 v[232:233], v[232:233], v[208:209]
    v_pk_add_f32 v[234:235], v[234:235], v[210:211]
    v_pk_add_f32 v[236:237], v[236:237], v[212:213]
    v_pk_add_f32 v[238:239], v[238:239], v[214:215]
    s_waitcnt lgkmcnt(4)
    s_nop 0
    v_mfma_f32_16x16x32_bf16 a[120:123], a[192:195], a[96:99], 0
    v_cvt_pk_bf16_f32 v240, v216, v217
    v_cvt_pk_bf16_f32 v241, v218, v219
    v_mfma_f32_16x16x32_bf16 a[124:127], a[196:199], a[96:99], 0
    v_cvt_pk_bf16_f32 v242, v220, v221
    v_cvt_pk_bf16_f32 v243, v222, v223
    v_mfma_f32_16x16x32_bf16 a[128:131], a[200:203], a[96:99], 0
    buffer_store_dwordx4 v[240:243], v4, s[44:47], 0 offen offset:0 sc0 sc1
    ds_write_b128 v2, v[32:35] offset:4352
    v_mfma_f32_16x16x32_bf16 a[120:123], a[204:207], a[100:103], a[120:123]
    v_cvt_pk_bf16_f32 v244, v224, v225
    v_cvt_pk_bf16_f32 v245, v226, v227
    v_mfma_f32_16x16x32_bf16 a[124:127], a[208:211], a[100:103], a[124:127]
    v_cvt_pk_bf16_f32 v246, v228, v229
    v_cvt_pk_bf16_f32 v247, v230, v231
    v_mfma_f32_16x16x32_bf16 a[128:131], a[212:215], a[100:103], a[128:131]
    buffer_store_dwordx4 v[244:247], v4, s[44:47], 0 offen offset:64 sc0 sc1
    ds_write_b128 v2, v[36:39] offset:5440
    v_mfma_f32_16x16x32_bf16 a[120:123], a[144:147], a[104:107], a[120:123]
    v_cvt_pk_bf16_f32 v248, v232, v233
    v_cvt_pk_bf16_f32 v249, v234, v235
    v_mfma_f32_16x16x32_bf16 a[124:127], a[148:151], a[104:107], a[124:127]
    v_cvt_pk_bf16_f32 v250, v236, v237
    v_cvt_pk_bf16_f32 v251, v238, v239
    v_mfma_f32_16x16x32_bf16 a[128:131], a[152:155], a[104:107], a[128:131]
    buffer_store_dwordx4 v[248:251], v4, s[44:47], 0 offen offset:128 sc0 sc1
    ds_write_b128 v2, v[40:43] offset:6528
    v_mfma_f32_16x16x32_bf16 a[120:123], a[156:159], a[108:111], a[120:123]
    v_mfma_f32_16x16x32_bf16 a[124:127], a[160:163], a[108:111], a[124:127]
    ds_write_b128 v2, v[44:47] offset:7616
    v_mfma_f32_16x16x32_bf16 a[128:131], a[164:167], a[108:111], a[128:131]
    v_mfma_f32_16x16x32_bf16 a[120:123], a[168:171], a[112:115], a[120:123]
    ds_write_b128 v2, v[48:51] offset:8704
    v_mfma_f32_16x16x32_bf16 a[124:127], a[172:175], a[112:115], a[124:127]
    v_mfma_f32_16x16x32_bf16 a[128:131], a[176:179], a[112:115], a[128:131]
    ds_write_b128 v2, v[52:55] offset:9792
    s_waitcnt vmcnt(3) lgkmcnt(2)
    s_barrier
    ds_read_b128 v[128:131], v3 offset:0
    ds_read_b128 v[80:83], v3 offset:13056
    ds_read_b128 v[132:135], v3 offset:512
    ds_read_b128 v[84:87], v3 offset:13568
    v_mfma_f32_16x16x32_bf16 a[120:123], a[180:183], a[116:119], a[120:123]
    v_mfma_f32_16x16x32_bf16 a[124:127], a[184:187], a[116:119], a[124:127]
    ds_write_b128 v2, v[56:59] offset:10880
    v_mfma_f32_16x16x32_bf16 a[128:131], a[188:191], a[116:119], a[128:131]
    ds_write_b128 v2, v[60:63] offset:11968
    ds_read_b128 v[136:139], v3 offset:4352
    ds_read_b128 v[88:91], v3 offset:17408
    ds_read_b128 v[140:143], v3 offset:4864
    ds_read_b128 v[92:95], v3 offset:17920
    ds_write_b128 v7, a[120:123] offset:0
    s_waitcnt lgkmcnt(9)
    v_pk_add_f32 v[128:129], v[128:129], v[80:81]
    v_pk_add_f32 v[130:131], v[130:131], v[82:83]
    s_waitcnt lgkmcnt(7)
    v_pk_add_f32 v[132:133], v[132:133], v[84:85]
    v_pk_add_f32 v[134:135], v[134:135], v[86:87]
    v_dot2_f32_bf16 v128, v192, s68, v128
    v_dot2_f32_bf16 v129, v192, s69, v129
    v_dot2_f32_bf16 v130, v193, s68, v130
    v_dot2_f32_bf16 v131, v193, s69, v131
    v_dot2_f32_bf16 v132, v194, s68, v132
    v_dot2_f32_bf16 v133, v194, s69, v133
    v_dot2_f32_bf16 v134, v195, s68, v134
    v_dot2_f32_bf16 v135, v195, s69, v135
    ds_write_b128 v7, a[124:127] offset:1088
    v_cvt_pk_bf16_f32 v64, v128, v129
    v_cvt_pk_bf16_f32 v65, v130, v131
    v_cvt_pk_bf16_f32 v66, v132, v133
    v_cvt_pk_bf16_f32 v67, v134, v135
    buffer_store_dwordx4 v[64:67], v11, s[44:47], 0 offen offset:0 sc0 sc1
    ds_write_b128 v7, a[128:131] offset:2176
    s_waitcnt lgkmcnt(5)
    v_pk_add_f32 v[136:137], v[136:137], v[88:89]
    v_pk_add_f32 v[138:139], v[138:139], v[90:91]
    s_waitcnt lgkmcnt(3)
    v_pk_add_f32 v[140:141], v[140:141], v[92:93]
    v_pk_add_f32 v[142:143], v[142:143], v[94:95]
    v_dot2_f32_bf16 v136, v196, s68, v136
    v_dot2_f32_bf16 v137, v196, s69, v137
    v_dot2_f32_bf16 v138, v197, s68, v138
    v_dot2_f32_bf16 v139, v197, s69, v139
    v_dot2_f32_bf16 v140, v198, s68, v140
    v_dot2_f32_bf16 v141, v198, s69, v141
    v_dot2_f32_bf16 v142, v199, s68, v142
    v_dot2_f32_bf16 v143, v199, s69, v143
    s_waitcnt lgkmcnt(0)
    s_barrier
    ds_read_b128 v[144:147], v3 offset:8704
    ds_read_b128 v[96:99], v3 offset:21760
    ds_read_b128 v[148:151], v3 offset:9216
    ds_read_b128 v[100:103], v3 offset:22272
    ds_read_b128 v[112:115], v8 offset:0
    ds_read_b128 v[116:119], v8 offset:3264
    ds_read_b128 v[120:123], v8 offset:6528
    ds_read_b128 v[124:127], v8 offset:9792
    v_cvt_pk_bf16_f32 v68, v136, v137
    v_cvt_pk_bf16_f32 v69, v138, v139
    v_cvt_pk_bf16_f32 v70, v140, v141
    v_cvt_pk_bf16_f32 v71, v142, v143
    buffer_store_dwordx4 v[68:71], v11, s[44:47], 0 offen offset:64 sc0 sc1
    s_waitcnt lgkmcnt(4)
    s_nop 0
    v_pk_add_f32 v[144:145], v[144:145], v[96:97]
    v_pk_add_f32 v[146:147], v[146:147], v[98:99]
    v_pk_add_f32 v[148:149], v[148:149], v[100:101]
    v_pk_add_f32 v[150:151], v[150:151], v[102:103]
    v_dot2_f32_bf16 v144, v200, s68, v144
    v_dot2_f32_bf16 v145, v200, s69, v145
    v_dot2_f32_bf16 v146, v201, s68, v146
    v_dot2_f32_bf16 v147, v201, s69, v147
    v_dot2_f32_bf16 v148, v202, s68, v148
    v_dot2_f32_bf16 v149, v202, s69, v149
    v_dot2_f32_bf16 v150, v203, s68, v150
    v_dot2_f32_bf16 v151, v203, s69, v151
    v_cvt_pk_bf16_f32 v72, v144, v145
    v_cvt_pk_bf16_f32 v73, v146, v147
    v_cvt_pk_bf16_f32 v74, v148, v149
    v_cvt_pk_bf16_f32 v75, v150, v151
    buffer_store_dwordx4 v[72:75], v11, s[44:47], 0 offen offset:128 sc0 sc1
    s_waitcnt lgkmcnt(0)
    s_nop 0
    v_pk_add_f32 v[112:113], v[112:113], v[116:117]
    v_pk_add_f32 v[120:121], v[120:121], v[124:125]
    v_pk_add_f32 v[114:115], v[114:115], v[118:119]
    v_pk_add_f32 v[122:123], v[122:123], v[126:127]
    v_pk_add_f32 v[128:129], v[112:113], v[120:121]
    v_pk_add_f32 v[130:131], v[114:115], v[122:123]
    v_dot2_f32_bf16 v128, v76, s68, v128
    v_dot2_f32_bf16 v129, v76, s69, v129
    v_dot2_f32_bf16 v130, v77, s68, v130
    v_dot2_f32_bf16 v131, v77, s69, v131
    s_nop 0
    v_cvt_pk_bf16_f32 v112, v128, v129
    s_nop 0
    v_cvt_pk_bf16_f32 v113, v130, v131
    buffer_store_dwordx2 v[112:113], v10, s[44:47], 0 offen sc0 sc1
L_end:
    s_endpgm
.fill 1024, 4, 0xbf810000
.section .rodata,"a"
.p2align 6
.amdhsa_kernel standalone__modern_conv_block_replknet__vision_kernel
  .amdhsa_next_free_vgpr 512
  .amdhsa_next_free_sgpr 102
  .amdhsa_accum_offset 256
  .amdhsa_group_segment_fixed_size 0
  .amdhsa_kernarg_size 64
  .amdhsa_user_sgpr_count 2
  .amdhsa_user_sgpr_kernarg_segment_ptr 1
  .amdhsa_system_sgpr_workgroup_id_x 1
  .amdhsa_float_denorm_mode_32 3
.end_amdhsa_kernel
```
